```python
import torch

def _softmax(x, axis=-1):
    return torch.softmax(x, dim=axis)

def _gelu(x):
    return torch.nn.functional.gelu(x, approximate='tanh')

def _silu(x):
    return torch.nn.functional.silu(x)

def _sigmoid(x):
    return torch.sigmoid(x)

def _layernorm(x, axis=-1, eps=1e-05):
    m = x.mean(dim=axis, keepdim=True)
    v = x.var(dim=axis, keepdim=True, unbiased=False)
    return (x - m) / torch.sqrt(v + eps)

def _scatter_add(tgt, idx, src, axis=0):
    return tgt.clone().index_add_(axis, idx, src)

def _segment_sum(src, seg, n):
    out = torch.zeros((n,) + src.shape[1:], dtype=src.dtype)
    return out.index_add_(0, seg, src)

def _pad(x, pw):
    flat = tuple((v for pair in reversed(pw) for v in pair))
    return torch.nn.functional.pad(x, flat)
kernel_name = 'adaLN_cond__sliding_block_cached__dense_activation_silu__decode'

def setup_inputs():

    _w = lambda a: (lambda t: t.to(torch.bfloat16) if t.is_floating_point() else t)(torch.as_tensor(a))

    def _A_setup():
        B, Sq, D = (1, 1, 448)
        Hq, Hkv, Sk, Dh = (16, 8, 65536, 256)
        assert Hq % Hkv == 0, (Hq, Hkv)
        return {'x': _w((lambda *s: torch.randn(*s, dtype=torch.bfloat16) * 0.1)(B, Sq, D)), 'k_cache': _w((lambda *s: torch.randn(*s, dtype=torch.bfloat16) * 0.8)(B, Hkv, Sk, Dh)), 'v_cache': _w((lambda *s: torch.randn(*s, dtype=torch.bfloat16) * 3.2)(B, Hkv, Sk, Dh)), 'wq': _w((lambda *s: torch.randn(*s, dtype=torch.bfloat16) * 0.8)(D, Hq * Dh) * D ** (-0.5)), 'wo': _w((lambda *s: torch.randn(*s, dtype=torch.bfloat16) * 3.2)(Hq * Dh, D) * (Hq * Dh) ** (-0.5))}
    _A_in = _A_setup()

    def _B_setup():
        B, S, D, F = (1, 1, 448, 1792)
        return {'x': _w((lambda *s: torch.randn(*s, dtype=torch.bfloat16) * 0.1)(B, S, D)), 'w1': _w((lambda *s: torch.randn(*s, dtype=torch.bfloat16) * 3.2)(D, F) * D ** (-0.5)), 'w2': _w((lambda *s: torch.randn(*s, dtype=torch.bfloat16) * 3.2)(F, D) * F ** (-0.5))}
    _B_in = _B_setup()
    return {'A_x': _A_in['x'], 'A_k_cache': _A_in['k_cache'], 'A_v_cache': _A_in['v_cache'], 'A_wq': _A_in['wq'], 'A_wo': _A_in['wo'], 'B_x': _B_in['x'], 'B_w1': _B_in['w1'], 'B_w2': _B_in['w2'], 'c': _w((lambda *s: torch.randn(*s, dtype=torch.bfloat16) * 0.4)(1, 448) * 8.0), 'w_mod': _w((lambda *s: torch.randn(*s, dtype=torch.bfloat16) * 0.4)(448, 6 * 448) * 448 ** (-0.5) * 8.0)}

def reference(A_x, A_k_cache, A_v_cache, A_wq, A_wo, B_x, B_w1, B_w2, c, w_mod):

    def _A_ref(x, k_cache, v_cache, wq, wo):
        B, Sq, D = x.shape
        Hq, Dh = (16, 256)
        Hkv, Sk = (k_cache.shape[1], k_cache.shape[2])
        W = min(4096, max(256, Sk // 4))
        rep = Hq // Hkv
        q = (lambda x, *d: x.permute(*d))((x @ wq).reshape(B, Sq, Hq, Dh), 0, 2, 1, 3)
        k = (lambda x, n, axis: torch.repeat_interleave(x, n, dim=axis))(k_cache[:, :, Sk - W:, :], rep, axis=1)
        v = (lambda x, n, axis: torch.repeat_interleave(x, n, dim=axis))(v_cache[:, :, Sk - W:, :], rep, axis=1)
        scores = torch.einsum('bhqd,bhkd->bhqk', q, k) * Dh ** (-0.5)
        p = _softmax(scores, axis=-1)
        o = torch.einsum('bhqk,bhkd->bhqd', p, v)
        return (lambda x, *d: x.permute(*d))(o, 0, 2, 1, 3).reshape(B, Sq, Hq * Dh) @ wo

    def _B_ref(x, w1, w2):
        h = torch.einsum('bsd,df->bsf', x, w1)
        h = _silu(h)
        out = torch.einsum('bsf,fd->bsd', h, w2)
        return out
    x = A_x
    mod = (_silu(c) @ w_mod).reshape(c.shape[0], 6, 1, -1)
    sa, ca, ga, sb, cb, gb = (mod[:, 0].clone(), mod[:, 1].clone(), mod[:, 2].clone(), mod[:, 3].clone(), mod[:, 4].clone(), mod[:, 5].clone())
    h = _layernorm(x, axis=-1) * (1 + ca) + sa
    x = x + ga * _A_ref(h, A_k_cache, A_v_cache, A_wq, A_wo)
    h = _layernorm(x, axis=-1) * (1 + cb) + sb
    x = x + gb * _B_ref(h, B_w1, B_w2)
    return x
```

```asm
; @launch grid=(256,1,1) block=(704,1,1) lds=162304
.amdgcn_target "amdgcn-amd-amdhsa--gfx950"
.text
.globl adaLN_cond__sliding_block_cached__dense_activation_silu__decode_kernel
.p2align 12
.fill 832, 4, 0xbf810000
.p2align 8
.type adaLN_cond__sliding_block_cached__dense_activation_silu__decode_kernel,@function
adaLN_cond__sliding_block_cached__dense_activation_silu__decode_kernel:
s_load_dwordx16 s[4:19], s[0:1], 0
s_load_dwordx8 s[20:27], s[0:1], 64
s_load_dwordx2 s[28:29], s[0:1], 96
s_cmp_ge_u32 s2, 16
s_cbranch_scc1 L_npf
s_getpc_b64 s[48:49]
L_pc:
v_lshlrev_b32 v2, 7, v0
v_cmp_gt_u32 vcc, L_last-L_pc, v2
s_and_b64 exec, exec, vcc
s_cbranch_execz L_npf2
global_load_dword v14, v2, s[48:49]
L_npf2:
s_mov_b64 exec, -1
L_npf:
s_cmp_ge_u32 s2, 256
s_cbranch_scc1 L_exit
v_lshrrev_b32 v2, 6, v0
v_and_b32 v1, 63, v0
s_and_b32 s31, s2, 7
s_lshr_b32 s32, s2, 3
v_readfirstlane_b32 s3, v2
s_cmp_gt_u32 s31, 5
s_subb_u32 s33, s31, 0
s_cmp_eq_u32 s31, 5
s_cselect_b32 s33, 7, s33
s_cselect_b32 s48, 8, 10
s_cselect_b32 s42, 0, 0x24c000
s_cselect_b32 s49, 32, 28
s_cmp_lt_u32 s32, s48
s_cselect_b32 s58, 2, 0
s_cmp_lt_u32 s32, 8
s_cselect_b32 s58, 1, s58
s_cmp_ge_u32 s32, s49
s_cselect_b32 s58, 3, s58
s_mov_b32 s38, 0x400000
s_mov_b32 s39, 0x20000
s_mov_b32 s43, 0x20000
s_mov_b32 s47, 0x20000
s_mov_b32 s46, 0x380000
v_and_b32 v8, 15, v1
v_lshrrev_b32 v9, 4, v1
s_cmp_ge_u32 s3, 2
s_cbranch_scc1 L_aux
v_lshlrev_b32 v3, 4, v1
v_mul_u32_u24 v2, 5376, v9
v_lshl_add_u32 v2, v8, 4, v2
s_lshl_b32 s51, s32, 1
s_add_u32 s51, s51, s3
s_sub_u32 s50, s51, 4
s_cmp_lt_u32 s32, 8
s_cselect_b32 s50, s51, s50
s_mul_i32 s52, s50, 21504
s_lshl_b32 s48, s33, 8
s_add_u32 s52, s52, s48
s_add_u32 s54, s52, 1290240
s_lshl_b32 s53, s50, 13
s_lshl_b32 s48, s31, 10
s_add_u32 s53, s53, s48
s_mov_b32 s49, 491520
s_lshr_b32 s48, s32, 1
s_waitcnt lgkmcnt(0)
s_mov_b64 s[40:41], s[22:23]
s_mov_b64 s[44:45], s[10:11]
s_cmp_eq_u32 s48, 4
s_cbranch_scc1 L_s1m
buffer_load_dwordx4 v[16:19], v2, s[40:43], s52 offen
buffer_load_dwordx4 v[16:19], v2, s[40:43], s54 offen
buffer_load_dwordx4 v[16:19], v3, s[44:47], s53 offen
s_add_u32 s53, s53, s49
buffer_load_dwordx4 v[16:19], v3, s[44:47], s53 offen
s_add_u32 s53, s53, s49
buffer_load_dwordx4 v[16:19], v3, s[44:47], s53 offen
s_add_u32 s53, s53, s49
buffer_load_dwordx4 v[16:19], v3, s[44:47], s53 offen
s_add_u32 s53, s53, s49
buffer_load_dwordx4 v[16:19], v3, s[44:47], s53 offen
s_add_u32 s53, s53, s49
buffer_load_dwordx4 v[16:19], v3, s[44:47], s53 offen
s_add_u32 s53, s53, s49
buffer_load_dwordx4 v[16:19], v3, s[44:47], s53 offen
s_add_u32 s53, s53, s49
buffer_load_dwordx4 v[16:19], v3, s[44:47], s53 offen
s_branch L_s2
L_s1m:
v_min_u32 v2, 0x370, v3
global_load_dword v16, v2, s[20:21]
global_load_dword v16, v2, s[4:5]
s_branch L_s2
L_aux:
v_mov_b32 v30, 0
v_lshlrev_b32 v27, 2, v1
s_sub_u32 s35, s3, 3
s_lshl_b32 s52, s33, 1
s_add_u32 s52, s52, s32
s_sub_u32 s52, s52, 8
s_waitcnt lgkmcnt(0)
s_mov_b64 s[36:37], s[28:29]
s_cmp_lg_u32 s3, 2
s_cbranch_scc1 L_a1
s_mov_b64 exec, 1
buffer_load_dword v17, v30, s[36:39], 0 offen sc1
s_mov_b64 exec, -1
s_branch L_svc
L_a1:
s_cmp_eq_u32 s35, 7
s_cbranch_scc1 L_finx
s_cmp_lg_u32 s58, 2
s_cbranch_scc1 L_gdone
L_gmod:
s_lshl_b32 s50, s35, 7
v_lshl_add_u32 v2, v1, 1, s50
global_load_ushort v10, v2, s[20:21]
s_movk_i32 s48, 5376
s_mov_b32 s42, 0x24c000
s_mov_b64 s[40:41], s[22:23]
s_mul_i32 s49, s35, 344064
s_lshl_b32 s50, s52, 7
s_add_u32 s49, s49, s50
L_gload:
s_lshl_b32 s50, s48, 3
v_lshrrev_b32 v2, 3, v1
v_mul_u32_u24 v2, s50, v2
v_and_b32 v3, 7, v1
v_lshl_add_u32 v2, v3, 4, v2
buffer_load_dwordx4 v[32:35], v2, s[40:43], s49 offen
s_add_u32 s49, s49, s48
buffer_load_dwordx4 v[36:39], v2, s[40:43], s49 offen
s_add_u32 s49, s49, s48
buffer_load_dwordx4 v[40:43], v2, s[40:43], s49 offen
s_add_u32 s49, s49, s48
buffer_load_dwordx4 v[44:47], v2, s[40:43], s49 offen
s_add_u32 s49, s49, s48
buffer_load_dwordx4 v[48:51], v2, s[40:43], s49 offen
s_add_u32 s49, s49, s48
buffer_load_dwordx4 v[52:55], v2, s[40:43], s49 offen
s_add_u32 s49, s49, s48
buffer_load_dwordx4 v[56:59], v2, s[40:43], s49 offen
s_add_u32 s49, s49, s48
buffer_load_dwordx4 v[60:63], v2, s[40:43], s49 offen
s_cmp_lg_u32 s58, 2
s_cbranch_scc1 L_grel
s_branch L_gdone
L_s2:
s_sub_u32 s68, s32, 10
s_cmp_lt_u32 s68, 14
s_cselect_b32 s70, 16, 0
s_cmp_ge_u32 s68, 7
s_cselect_b32 s49, 1, 0
s_mul_i32 s48, s49, 7
s_sub_u32 s68, s68, s48
s_lshl_b32 s48, s31, 1
s_add_u32 s48, s48, s49
s_lshl_b32 s48, s48, 5
s_movk_i32 s69, 896
s_mov_b64 s[64:65], s[12:13]
s_mov_b32 s66, 0x380000
s_mov_b32 s67, 0x20000
s_lshr_b32 s49, s32, 2
s_cmp_lg_u32 s49, 6
s_cbranch_scc1 L_dm2
s_lshl_b32 s68, s33, 2
s_add_u32 s68, s68, s32
s_sub_u32 s68, s68, 24
s_mov_b32 s48, 0
s_movk_i32 s69, 3584
s_mov_b64 s[64:65], s[16:17]
s_mov_b32 s66, 0x188000
s_cmp_lt_u32 s33, 7
s_cselect_b32 s70, 0, 0
L_dm2:
s_add_u32 s48, s48, s3
s_mul_i32 s48, s48, s69
s_lshl_b32 s48, s48, 3
s_lshl_b32 s68, s68, 7
s_add_u32 s68, s68, s48
v_lshrrev_b32 v21, 3, v1
v_mul_u32_u24 v21, s69, v21
v_and_b32 v2, 7, v1
v_lshl_add_u32 v21, v2, 4, v21
s_lshl_b32 s69, s69, 4
s_lshl_b32 s71, s3, 10
s_add_u32 m0, s71, 104960
s_movk_i32 s61, 68
s_mov_b32 s62, 1
s_cmp_ge_u32 s32, 8
s_cselect_b32 s60, 4, 16
s_cselect_b32 s61, 12, s61
s_cselect_b32 s62, 10, s62
s_cmp_ge_u32 s32, 10
s_cselect_b32 s60, 28, s60
s_cselect_b32 s61, -20, s61
s_cselect_b32 s62, 1, s62
s_cmp_ge_u32 s32, 24
s_cselect_b32 s60, 8, s60
s_cselect_b32 s61, 36, s61
s_cselect_b32 s62, 14, s62
s_cmp_ge_u32 s32, 28
s_cselect_b32 s61, 140, s61
s_cselect_b32 s62, 4, s62
s_cmp_eq_u32 s33, 7
s_cselect_b32 s62, 0, s62
s_add_u32 s61, s61, s51
s_mul_i32 s52, s61, 10752
s_lshl_b32 s48, s33, 9
s_add_u32 s52, s52, s48
s_add_u32 s52, s52, 1792
s_mul_i32 s60, s60, 10752
v_lshrrev_b32 v2, 5, v1
v_and_b32 v10, 31, v1
s_lshl_b32 s48, s3, 1
v_mul_u32_u24 v20, 5376, v2
v_lshl_add_u32 v20, v10, 4, v20
v_xor_b32 v10, v2, v10
v_xor_b32 v10, s48, v10
v_lshlrev_b32 v2, 9, v2
v_lshl_add_u32 v10, v10, 4, v2
v_add_u32 v10, s71, v10
v_xor_b32 v11, 64, v10
v_xor_b32 v12, 0x80, v10
v_xor_b32 v13, 0xc0, v10
s_lshl_b32 s54, s31, 6
s_add_u32 s54, s54, s51
s_lshl_b32 s54, s54, 10
s_add_u32 s54, s54, 524288
s_mov_b64 s[36:37], s[28:29]
s_lshl_b32 s50, s31, 25
s_lshl_b32 s49, s32, 16
s_add_u32 s50, s50, s49
s_add_u32 s50, s50, 0x1e00000
s_add_u32 s72, s6, s50
s_addc_u32 s73, s7, 0
s_add_u32 s44, s8, s50
s_addc_u32 s45, s9, 0
s_mov_b32 s74, 0x10000
s_mov_b32 s75, 0x20000
s_mov_b32 s46, 0x10000
s_mul_i32 s51, s32, 4096
s_mul_i32 s49, s31, 2048
s_add_u32 s51, s51, s49
s_mov_b32 s59, 0xffff
s_and_b32 s51, s51, s59
s_mov_b32 s53, 0
s_cmp_eq_u32 s58, 3
s_cselect_b32 s55, 4, 3
s_cmp_eq_u32 s58, 1
s_cselect_b32 s55, 3, s55
s_cmp_ge_u32 s32, 10
s_cbranch_scc1 L_u3c
s_waitcnt vmcnt(0)
s_barrier
s_cmp_lg_u32 s58, 1
s_cbranch_scc1 L_u3c
s_mov_b32 s97, 0
v_mov_b32 v5, 0
L_spin1:
ds_read_b32 v4, v5 offset:60
s_add_u32 s97, s97, 1
s_bitcmp1_b32 s97, 20
s_cbranch_scc1 L_end
s_waitcnt lgkmcnt(0)
v_cmp_ne_u32 vcc, 7, v4
s_cbranch_vccnz L_spin1
s_branch L_u3c
L_u3l:
s_waitcnt vmcnt(10)
buffer_load_dwordx4 v[16:19], v20, s[40:43], s52 offen
s_add_u32 s52, s52, s60
s_sub_u32 s62, s62, 1
L_u3c:
s_cmp_lg_u32 s62, 0
s_cbranch_scc1 L_u3l
s_branch L_dmc
L_dml:
s_waitcnt vmcnt(10)
buffer_load_dwordx4 v21, s[64:67], s68 offen  lds
s_add_u32 s68, s68, s69
s_add_u32 m0, m0, 2048
s_sub_u32 s70, s70, 1
L_dmc:
s_cmp_lg_u32 s70, 0
s_cbranch_scc1 L_dml
s_add_u32 m0, s71, 39424
L_kloop:
s_cmp_eq_u32 s53, s55
s_cbranch_scc1 L_kd
L_kgo2:
s_waitcnt vmcnt(10)
buffer_load_dwordx4 v10, s[72:75], s51 offen nt lds
s_addk_i32 s51, 2048
s_add_u32 m0, m0, 2048
s_and_b32 s51, s51, s59
s_waitcnt vmcnt(10)
buffer_load_dwordx4 v11, s[72:75], s51 offen nt lds
s_addk_i32 s51, 2048
s_add_u32 m0, m0, 2048
s_and_b32 s51, s51, s59
s_waitcnt vmcnt(10)
buffer_load_dwordx4 v12, s[72:75], s51 offen nt lds
s_addk_i32 s51, 2048
s_add_u32 m0, m0, 2048
s_and_b32 s51, s51, s59
s_waitcnt vmcnt(10)
buffer_load_dwordx4 v13, s[72:75], s51 offen nt lds
s_addk_i32 s51, 2048
s_add_u32 m0, m0, 2048
s_and_b32 s51, s51, s59
s_add_u32 s53, s53, 1
s_cmp_lt_u32 s53, 8
s_cbranch_scc1 L_kloop
v_lshlrev_b32 v8, 4, v8
v_mul_u32_u24 v1, 272, v9
v_add_u32 v1, v1, v8
s_lshl_b32 s48, s3, 8
v_lshl_add_u32 v2, v9, 9, v8
v_add_u32 v2, s48, v2
v_mov_b32 v152, 0
v_mov_b32 v153, 1
v_mov_b64 v[4:5], 0
v_mov_b64 v[6:7], 0
s_waitcnt vmcnt(11)
s_mov_b64 exec, 1
ds_add_u32 v152, v153 offset:192
s_mov_b64 exec, -1
buffer_load_dwordx4 v[24:27], v2, s[44:47], s51 offen nt
s_addk_i32 s51, 2048
s_and_b32 s51, s51, s59
s_waitcnt vmcnt(11)
buffer_load_dwordx4 v[28:31], v2, s[44:47], s51 offen nt
s_addk_i32 s51, 2048
s_and_b32 s51, s51, s59
s_waitcnt vmcnt(11)
buffer_load_dwordx4 v[32:35], v2, s[44:47], s51 offen nt
s_addk_i32 s51, 2048
s_and_b32 s51, s51, s59
s_waitcnt vmcnt(11)
s_mov_b64 exec, 1
ds_add_u32 v152, v153 offset:196
s_mov_b64 exec, -1
buffer_load_dwordx4 v[36:39], v2, s[44:47], s51 offen nt
s_addk_i32 s51, 2048
s_and_b32 s51, s51, s59
s_waitcnt vmcnt(11)
buffer_load_dwordx4 v[40:43], v2, s[44:47], s51 offen nt
s_addk_i32 s51, 2048
s_and_b32 s51, s51, s59
s_waitcnt vmcnt(11)
s_mov_b64 exec, 1
ds_add_u32 v152, v153 offset:56
s_mov_b64 exec, -1
buffer_load_dwordx4 v[44:47], v2, s[44:47], s51 offen nt
s_addk_i32 s51, 2048
s_and_b32 s51, s51, s59
s_waitcnt vmcnt(11)
buffer_load_dwordx4 v[48:51], v2, s[44:47], s51 offen nt
s_addk_i32 s51, 2048
s_and_b32 s51, s51, s59
s_waitcnt vmcnt(11)
s_mov_b64 exec, 1
ds_add_u32 v152, v153 offset:200
s_mov_b64 exec, -1
buffer_load_dwordx4 v[52:55], v2, s[44:47], s51 offen nt
s_addk_i32 s51, 2048
s_and_b32 s51, s51, s59
s_waitcnt vmcnt(11)
buffer_load_dwordx4 v[56:59], v2, s[44:47], s51 offen nt
s_addk_i32 s51, 2048
s_and_b32 s51, s51, s59
s_waitcnt vmcnt(11)
buffer_load_dwordx4 v[60:63], v2, s[44:47], s51 offen nt
s_addk_i32 s51, 2048
s_and_b32 s51, s51, s59
s_waitcnt vmcnt(11)
buffer_load_dwordx4 v[64:67], v2, s[44:47], s51 offen nt
s_addk_i32 s51, 2048
s_and_b32 s51, s51, s59
s_waitcnt vmcnt(11)
s_mov_b64 exec, 1
ds_add_u32 v152, v153 offset:204
s_mov_b64 exec, -1
buffer_load_dwordx4 v[68:71], v2, s[44:47], s51 offen nt
s_addk_i32 s51, 2048
s_and_b32 s51, s51, s59
s_waitcnt vmcnt(11)
buffer_load_dwordx4 v[72:75], v2, s[44:47], s51 offen nt
s_addk_i32 s51, 2048
s_and_b32 s51, s51, s59
s_waitcnt vmcnt(11)
buffer_load_dwordx4 v[76:79], v2, s[44:47], s51 offen nt
s_addk_i32 s51, 2048
s_and_b32 s51, s51, s59
s_waitcnt vmcnt(11)
buffer_load_dwordx4 v[80:83], v2, s[44:47], s51 offen nt
s_addk_i32 s51, 2048
s_and_b32 s51, s51, s59
s_waitcnt vmcnt(11)
buffer_load_dwordx4 v[84:87], v2, s[44:47], s51 offen nt
s_addk_i32 s51, 2048
s_and_b32 s51, s51, s59
s_waitcnt vmcnt(11)
buffer_load_dwordx4 v[88:91], v2, s[44:47], s51 offen nt
s_addk_i32 s51, 2048
s_and_b32 s51, s51, s59
s_waitcnt vmcnt(11)
buffer_load_dwordx4 v[92:95], v2, s[44:47], s51 offen nt
s_addk_i32 s51, 2048
s_and_b32 s51, s51, s59
s_waitcnt vmcnt(11)
buffer_load_dwordx4 v[96:99], v2, s[44:47], s51 offen nt
s_addk_i32 s51, 2048
s_and_b32 s51, s51, s59
s_waitcnt vmcnt(11)
buffer_load_dwordx4 v[100:103], v2, s[44:47], s51 offen nt
s_addk_i32 s51, 2048
s_and_b32 s51, s51, s59
s_waitcnt vmcnt(11)
buffer_load_dwordx4 v[104:107], v2, s[44:47], s51 offen nt
s_addk_i32 s51, 2048
s_and_b32 s51, s51, s59
s_waitcnt vmcnt(11)
buffer_load_dwordx4 v[108:111], v2, s[44:47], s51 offen nt
s_addk_i32 s51, 2048
s_and_b32 s51, s51, s59
s_waitcnt vmcnt(11)
s_mov_b64 exec, 1
ds_add_u32 v152, v153 offset:20
s_mov_b64 exec, -1
buffer_load_dwordx4 v[112:115], v2, s[44:47], s51 offen nt
s_addk_i32 s51, 2048
s_and_b32 s51, s51, s59
s_waitcnt vmcnt(11)
buffer_load_dwordx4 v[116:119], v2, s[44:47], s51 offen nt
s_addk_i32 s51, 2048
s_and_b32 s51, s51, s59
s_waitcnt vmcnt(15)
buffer_load_dwordx4 v[120:123], v2, s[44:47], s51 offen nt
s_addk_i32 s51, 2048
s_and_b32 s51, s51, s59
s_waitcnt vmcnt(15)
buffer_load_dwordx4 v[124:127], v2, s[44:47], s51 offen nt
s_addk_i32 s51, 2048
s_and_b32 s51, s51, s59
s_waitcnt vmcnt(15)
buffer_load_dwordx4 v[128:131], v2, s[44:47], s51 offen nt
s_addk_i32 s51, 2048
s_and_b32 s51, s51, s59
s_waitcnt vmcnt(15)
buffer_load_dwordx4 v[132:135], v2, s[44:47], s51 offen nt
s_addk_i32 s51, 2048
s_and_b32 s51, s51, s59
s_waitcnt vmcnt(15)
buffer_load_dwordx4 v[136:139], v2, s[44:47], s51 offen nt
s_addk_i32 s51, 2048
s_and_b32 s51, s51, s59
s_waitcnt vmcnt(15)
buffer_load_dwordx4 v[140:143], v2, s[44:47], s51 offen nt
s_addk_i32 s51, 2048
s_and_b32 s51, s51, s59
s_waitcnt vmcnt(15)
buffer_load_dwordx4 v[144:147], v2, s[44:47], s51 offen nt
s_addk_i32 s51, 2048
s_and_b32 s51, s51, s59
s_waitcnt vmcnt(15)
buffer_load_dwordx4 v[148:151], v2, s[44:47], s51 offen nt
s_mov_b32 s97, 0
v_mov_b32 v10, 0
L_gm2:
ds_read_b32 v12, v10 offset:0
s_add_u32 s97, s97, 1
s_bitcmp1_b32 s97, 20
s_cbranch_scc1 L_end
s_waitcnt lgkmcnt(0)
v_readfirstlane_b32 s96, v12
s_cmp_eq_u32 s96, 0
s_cbranch_scc1 L_gm2
s_mov_b32 s97, 0
v_mov_b32 v10, 0
L_spin3:
ds_read_b32 v12, v10 offset:16
s_add_u32 s97, s97, 1
s_bitcmp1_b32 s97, 20
s_cbranch_scc1 L_end
s_waitcnt lgkmcnt(0)
v_cmp_ne_u32 vcc, 8, v12
s_cbranch_vccnz L_spin3
ds_read_b128 v[8:11], v1 offset:4608
ds_read_b128 v[12:15], v1 offset:5696
ds_read_b128 v[16:19], v1 offset:6784
ds_read_b128 v[20:23], v1 offset:7872
ds_read_b128 v[156:159], v1 offset:8960
ds_read_b128 v[160:163], v1 offset:10048
s_cmp_eq_u32 s96, 2
ds_read_b128 v[164:167], v1 offset:11136
s_waitcnt lgkmcnt(6)
v_mfma_f32_16x16x32_bf16 v[4:7], v[8:11], v[24:27], v[4:7]
ds_read_b128 v[8:11], v1 offset:12224
s_waitcnt lgkmcnt(6)
v_mfma_f32_16x16x32_bf16 v[4:7], v[12:15], v[28:31], v[4:7]
ds_read_b128 v[12:15], v1 offset:13312
s_waitcnt lgkmcnt(6)
v_mfma_f32_16x16x32_bf16 v[4:7], v[16:19], v[32:35], v[4:7]
ds_read_b128 v[16:19], v1 offset:14400
s_waitcnt lgkmcnt(6)
v_mfma_f32_16x16x32_bf16 v[4:7], v[20:23], v[36:39], v[4:7]
ds_read_b128 v[20:23], v1 offset:15488
s_waitcnt lgkmcnt(6)
v_mfma_f32_16x16x32_bf16 v[4:7], v[156:159], v[40:43], v[4:7]
ds_read_b128 v[156:159], v1 offset:16576
s_waitcnt lgkmcnt(6)
v_mfma_f32_16x16x32_bf16 v[4:7], v[160:163], v[44:47], v[4:7]
ds_read_b128 v[160:163], v1 offset:17664
s_waitcnt lgkmcnt(6)
v_mfma_f32_16x16x32_bf16 v[4:7], v[164:167], v[48:51], v[4:7]
ds_read_b128 v[164:167], v1 offset:18752
s_waitcnt lgkmcnt(6)
v_mfma_f32_16x16x32_bf16 v[4:7], v[8:11], v[52:55], v[4:7]
ds_read_b128 v[8:11], v1 offset:19840
s_waitcnt lgkmcnt(6)
v_mfma_f32_16x16x32_bf16 v[4:7], v[12:15], v[56:59], v[4:7]
ds_read_b128 v[12:15], v1 offset:20928
s_waitcnt lgkmcnt(6)
v_mfma_f32_16x16x32_bf16 v[4:7], v[16:19], v[60:63], v[4:7]
ds_read_b128 v[16:19], v1 offset:22016
s_waitcnt lgkmcnt(6)
v_mfma_f32_16x16x32_bf16 v[4:7], v[20:23], v[64:67], v[4:7]
ds_read_b128 v[20:23], v1 offset:23104
s_waitcnt lgkmcnt(6)
v_mfma_f32_16x16x32_bf16 v[4:7], v[156:159], v[68:71], v[4:7]
ds_read_b128 v[156:159], v1 offset:24192
s_waitcnt lgkmcnt(6)
v_mfma_f32_16x16x32_bf16 v[4:7], v[160:163], v[72:75], v[4:7]
ds_read_b128 v[160:163], v1 offset:25280
s_waitcnt lgkmcnt(6)
v_mfma_f32_16x16x32_bf16 v[4:7], v[164:167], v[76:79], v[4:7]
ds_read_b128 v[164:167], v1 offset:26368
s_waitcnt lgkmcnt(6)
v_mfma_f32_16x16x32_bf16 v[4:7], v[8:11], v[80:83], v[4:7]
ds_read_b128 v[8:11], v1 offset:27456
s_waitcnt lgkmcnt(6)
v_mfma_f32_16x16x32_bf16 v[4:7], v[12:15], v[84:87], v[4:7]
ds_read_b128 v[12:15], v1 offset:28544
s_waitcnt vmcnt(15) lgkmcnt(6)
v_mfma_f32_16x16x32_bf16 v[4:7], v[16:19], v[88:91], v[4:7]
ds_read_b128 v[16:19], v1 offset:29632
s_waitcnt vmcnt(14) lgkmcnt(6)
v_mfma_f32_16x16x32_bf16 v[4:7], v[20:23], v[92:95], v[4:7]
ds_read_b128 v[20:23], v1 offset:30720
s_waitcnt vmcnt(13) lgkmcnt(6)
v_mfma_f32_16x16x32_bf16 v[4:7], v[156:159], v[96:99], v[4:7]
ds_read_b128 v[156:159], v1 offset:31808
s_waitcnt vmcnt(12) lgkmcnt(6)
v_mfma_f32_16x16x32_bf16 v[4:7], v[160:163], v[100:103], v[4:7]
ds_read_b128 v[160:163], v1 offset:32896
s_waitcnt vmcnt(11) lgkmcnt(6)
v_mfma_f32_16x16x32_bf16 v[4:7], v[164:167], v[104:107], v[4:7]
ds_read_b128 v[164:167], v1 offset:33984
s_waitcnt vmcnt(10) lgkmcnt(6)
v_mfma_f32_16x16x32_bf16 v[4:7], v[8:11], v[108:111], v[4:7]
ds_read_b128 v[8:11], v1 offset:35072
s_waitcnt vmcnt(9) lgkmcnt(6)
v_mfma_f32_16x16x32_bf16 v[4:7], v[12:15], v[112:115], v[4:7]
ds_read_b128 v[12:15], v1 offset:36160
s_waitcnt vmcnt(8) lgkmcnt(6)
v_mfma_f32_16x16x32_bf16 v[4:7], v[16:19], v[116:119], v[4:7]
ds_read_b128 v[16:19], v1 offset:37248
s_waitcnt vmcnt(7) lgkmcnt(6)
v_mfma_f32_16x16x32_bf16 v[4:7], v[20:23], v[120:123], v[4:7]
ds_read_b128 v[20:23], v1 offset:38336
s_waitcnt vmcnt(6) lgkmcnt(6)
v_mfma_f32_16x16x32_bf16 v[4:7], v[156:159], v[124:127], v[4:7]
s_waitcnt vmcnt(5) lgkmcnt(5)
v_mfma_f32_16x16x32_bf16 v[4:7], v[160:163], v[128:131], v[4:7]
s_waitcnt vmcnt(4) lgkmcnt(4)
v_mfma_f32_16x16x32_bf16 v[4:7], v[164:167], v[132:135], v[4:7]
s_waitcnt vmcnt(3) lgkmcnt(3)
v_mfma_f32_16x16x32_bf16 v[4:7], v[8:11], v[136:139], v[4:7]
s_mov_b64 exec, 1
ds_add_u32 v152, v153 offset:28
s_mov_b64 exec, -1
s_waitcnt vmcnt(2) lgkmcnt(2)
s_nop 0
v_mfma_f32_16x16x32_bf16 v[4:7], v[12:15], v[140:143], v[4:7]
s_waitcnt vmcnt(1) lgkmcnt(1)
v_mfma_f32_16x16x32_bf16 v[4:7], v[16:19], v[144:147], v[4:7]
s_waitcnt vmcnt(0) lgkmcnt(0)
v_mfma_f32_16x16x32_bf16 v[4:7], v[20:23], v[148:151], v[4:7]
s_nop 6
s_cbranch_scc0 L_sm4s
buffer_store_dwordx4 v[4:7], v3, s[36:39], s54 offen
L_sm4d:
s_mov_b64 exec, 1
ds_add_u32 v152, v153 offset:44
s_mov_b64 exec, -1
s_branch L_end
L_kd:
s_cmp_lt_u32 s32, 10
s_cbranch_scc1 L_kd1
s_barrier
L_kd1:
v_mov_b32 v4, 0
v_mov_b32 v5, 1
s_mov_b64 exec, 1
ds_add_u32 v4, v5 offset:48
s_mov_b64 exec, -1
s_cmp_lg_u32 s58, 3
s_cbranch_scc1 L_kgo2
s_mov_b32 s97, 0
v_mov_b32 v5, 0
L_spin5:
ds_read_b32 v4, v5 offset:60
s_add_u32 s97, s97, 1
s_bitcmp1_b32 s97, 20
s_cbranch_scc1 L_end
s_waitcnt lgkmcnt(0)
v_cmp_ne_u32 vcc, 7, v4
s_cbranch_vccnz L_spin5
s_branch L_kgo2
L_gdone:
s_mov_b32 s56, 0x05040100
s_mov_b32 s57, 0x07060302
s_lshl_b32 s26, s35, 7
s_add_u32 s26, s26, 2304
v_lshrrev_b32 v2, 3, v1
v_lshl_add_u32 v2, v2, 4, s26
v_mov_b32 v3, 96
v_and_b32 v4, 4, v1
v_cmp_eq_u32 vcc, 0, v4
s_nop 1
v_cndmask_b32 v11, v3, v2, vcc
v_cndmask_b32 v31, v2, v3, vcc
v_and_b32 v2, 7, v1
v_lshlrev_b32 v30, 5, v2
v_and_b32 v2, 16, v1
v_add_u32 v30, v30, v2
v_lshrrev_b32 v2, 5, v1
v_lshl_add_u32 v30, v2, 3, v30
v_bfe_u32 v2, v1, 3, 1
v_lshl_add_u32 v30, v2, 2, v30
v_lshl_add_u32 v29, v1, 1, s26
s_lshl_b32 s27, s35, 8
v_add_u32 v28, s27, v30
s_mul_i32 s48, s35, 4352
v_mul_u32_u24 v2, 272, v9
v_lshl_add_u32 v2, v8, 4, v2
v_add_u32 v2, s48, v2
v_mov_b32 v12, 0
v_mov_b32 v13, 0
v_mov_b32 v14, 0
v_mov_b32 v15, 0
ds_write_b128 v2, v[12:15] offset:4608
ds_write_b128 v2, v[12:15] offset:5696
ds_write_b128 v2, v[12:15] offset:6784
ds_write_b128 v2, v[12:15] offset:7872
s_movk_i32 s48, 0x2000
s_mov_b32 s42, 0x380000
s_mov_b64 s[40:41], s[10:11]
s_lshl_b32 s49, s31, 3
s_add_u32 s49, s49, s32
s_lshl_b32 s49, s49, 7
s_lshl_b32 s50, s35, 19
s_add_u32 s49, s49, s50
s_barrier
ds_read_b32 v3, v12 offset:40
s_waitcnt lgkmcnt(0)
v_readfirstlane_b32 s30, v3
s_and_b32 s34, s30, 0xffff
s_cmp_eq_u32 s58, 0
s_cbranch_scc1 L_qfetch
s_cmp_eq_u32 s58, 3
s_cbranch_scc1 L_early
s_cmp_eq_u32 s35, 7
s_cbranch_scc1 L_fin
s_cmp_eq_u32 s58, 1
s_cbranch_scc1 L_gload
L_gsilu:
s_waitcnt vmcnt(8)
v_lshlrev_b32 v10, 16, v10
v_mul_f32 v2, 0xbfb8aa3b, v10
v_exp_f32 v2, v2
s_nop 0
v_add_f32 v2, 1.0, v2
v_rcp_f32 v2, v2
s_nop 0
v_mul_f32 v10, v10, v2
v_cvt_pk_bf16_f32 v2, v10, v10
ds_write_b16 v29, v2
ds_read_b128 v[16:19], v11
ds_read_b128 v[20:23], v31
L_perm:
s_waitcnt vmcnt(6)
v_perm_b32 v64, v36, v32, s56
v_perm_b32 v68, v36, v32, s57
v_perm_b32 v72, v37, v33, s56
v_perm_b32 v76, v37, v33, s57
v_perm_b32 v80, v38, v34, s56
v_perm_b32 v84, v38, v34, s57
v_perm_b32 v88, v39, v35, s56
v_perm_b32 v92, v39, v35, s57
s_waitcnt vmcnt(4)
v_perm_b32 v65, v44, v40, s56
v_perm_b32 v69, v44, v40, s57
v_perm_b32 v73, v45, v41, s56
v_perm_b32 v77, v45, v41, s57
v_perm_b32 v81, v46, v42, s56
v_perm_b32 v85, v46, v42, s57
v_perm_b32 v89, v47, v43, s56
v_perm_b32 v93, v47, v43, s57
s_waitcnt vmcnt(2)
v_perm_b32 v66, v52, v48, s56
v_perm_b32 v70, v52, v48, s57
v_perm_b32 v74, v53, v49, s56
v_perm_b32 v78, v53, v49, s57
v_perm_b32 v82, v54, v50, s56
v_perm_b32 v86, v54, v50, s57
v_perm_b32 v90, v55, v51, s56
v_perm_b32 v94, v55, v51, s57
s_waitcnt vmcnt(0)
v_perm_b32 v67, v60, v56, s56
v_perm_b32 v71, v60, v56, s57
v_perm_b32 v75, v61, v57, s56
v_perm_b32 v79, v61, v57, s57
v_perm_b32 v83, v62, v58, s56
v_perm_b32 v87, v62, v58, s57
v_perm_b32 v91, v63, v59, s56
v_perm_b32 v95, v63, v59, s57
s_cmp_lg_u32 s58, 1
s_cbranch_scc1 L_fmm
s_add_u32 s49, s27, 4096
s_mov_b32 s97, 0
v_mov_b32 v3, 0
L_spin6:
ds_read_b32 v2, v3 offset:48
s_add_u32 s97, s97, 1
s_bitcmp1_b32 s97, 20
s_cbranch_scc1 L_end
s_waitcnt lgkmcnt(0)
v_cmp_ne_u32 vcc, 2, v2
s_cbranch_vccnz L_spin6
s_mov_b32 s97, 0
L_pt7:
buffer_load_dword v4, v27, s[36:39], s49 offen sc1
buffer_load_dword v5, v27, s[36:39], s49 offen offset:1792 sc1
s_add_u32 s97, s97, 1
s_bitcmp1_b32 s97, 17
s_cbranch_scc1 L_end
s_waitcnt vmcnt(0)
v_xor_b32 v4, s34, v4
v_xor_b32 v5, s34, v5
v_or_b32 v2, v4, v5
v_cmp_ne_u16 vcc, 0, v2
s_cbranch_vccnz L_pt7
v_add_f32 v10, v4, v5
v_cvt_pk_bf16_f32 v2, v10, v10
ds_write_b16 v29, v2
ds_read_b128 v[16:19], v11
ds_read_b128 v[20:23], v31
L_fmm:
v_mov_b32 v2, 0
v_mov_b32 v3, 1
s_waitcnt lgkmcnt(1)
v_mfma_f32_16x16x32_bf16 v[96:99], v[16:19], v[64:67], 0
v_mfma_f32_16x16x32_bf16 v[100:103], v[16:19], v[68:71], 0
v_mfma_f32_16x16x32_bf16 v[104:107], v[16:19], v[72:75], 0
v_mfma_f32_16x16x32_bf16 v[108:111], v[16:19], v[76:79], 0
s_waitcnt lgkmcnt(0)
v_mfma_f32_16x16x32_bf16 v[96:99], v[20:23], v[80:83], v[96:99]
v_mfma_f32_16x16x32_bf16 v[100:103], v[20:23], v[84:87], v[100:103]
v_mfma_f32_16x16x32_bf16 v[104:107], v[20:23], v[88:91], v[104:107]
v_mfma_f32_16x16x32_bf16 v[108:111], v[20:23], v[92:95], v[108:111]
s_nop 6
v_permlane32_swap_b32 v96, v104
v_permlane32_swap_b32 v100, v108
s_nop 0
v_add_f32_dpp v96, v104, v96 row_ror:8 row_mask:0xf bank_mask:0x3
s_nop 1
v_add_f32_dpp v96, v100, v108 row_ror:8 row_mask:0xf bank_mask:0xc
ds_write_b32 v28, v96 offset:256
s_mov_b64 exec, 1
ds_add_u32 v2, v3 offset:24
s_mov_b64 exec, -1
s_branch L_qfetch
L_early:
s_lshl_b32 s52, s33, 2
s_add_u32 s52, s52, s32
s_sub_u32 s52, s52, 14
s_cmp_eq_u32 s35, 7
s_cbranch_scc1 L_finm
s_mov_b32 s97, 0
v_mov_b32 v3, 0
L_spin8:
ds_read_b32 v2, v3 offset:48
s_add_u32 s97, s97, 1
s_bitcmp1_b32 s97, 20
s_cbranch_scc1 L_end
s_waitcnt lgkmcnt(0)
v_cmp_ne_u32 vcc, 2, v2
s_cbranch_vccnz L_spin8
s_branch L_gmod
L_grel:
v_mov_b32 v2, 0
v_mov_b32 v3, 1
s_mov_b64 exec, 1
ds_add_u32 v2, v3 offset:60
s_mov_b64 exec, -1
s_cmp_eq_u32 s58, 1
s_cbranch_scc1 L_perm
s_branch L_gsilu
L_finx:
s_cmp_eq_u32 s58, 2
s_cbranch_scc1 L_finx2
s_cmp_lg_u32 s58, 1
s_cbranch_scc1 L_gdone
s_lshl_b32 s53, s31, 3
s_add_u32 s53, s53, s32
s_lshl_b32 s53, s53, 12
s_add_u32 s53, s53, 1048576
v_lshlrev_b32 v2, 6, v1
buffer_load_dword v16, v2, s[36:39], s53 offen sc1
s_branch L_gdone
L_finx2:
s_cmp_lt_u32 s52, 7
s_cbranch_scc1 L_gdone
v_lshlrev_b32 v3, 1, v1
s_sub_u32 s48, s52, 7
s_lshl_b32 s48, s48, 7
v_add_u32 v2, s48, v3
global_load_ushort v16, v3, s[4:5] offset:0
global_load_ushort v17, v3, s[4:5] offset:128
global_load_ushort v18, v3, s[4:5] offset:256
global_load_ushort v19, v3, s[4:5] offset:384
global_load_ushort v20, v3, s[4:5] offset:512
global_load_ushort v21, v3, s[4:5] offset:640
global_load_ushort v22, v3, s[4:5] offset:768
global_load_ushort v23, v2, s[4:5]
s_branch L_gdone
L_fin:
s_cmp_eq_u32 s58, 1
s_cbranch_scc1 L_finq
s_cmp_lt_u32 s52, 7
s_cbranch_scc1 L_finm
s_waitcnt vmcnt(0)
v_lshlrev_b32 v16, 16, v16
v_lshlrev_b32 v17, 16, v17
v_lshlrev_b32 v18, 16, v18
v_lshlrev_b32 v19, 16, v19
v_lshlrev_b32 v20, 16, v20
v_lshlrev_b32 v21, 16, v21
v_lshlrev_b32 v22, 16, v22
v_lshlrev_b32 v23, 16, v23
v_add_f32 v24, v16, v17
v_add_f32 v25, v18, v19
v_add_f32 v26, v20, v21
v_add_f32 v24, v24, v25
v_add_f32 v26, v26, v22
v_add_f32 v24, v24, v26
s_nop 1
v_add_f32_dpp v24, v24, v24 row_ror:8 row_mask:0xf bank_mask:0xf
s_nop 1
v_add_f32_dpp v24, v24, v24 row_ror:4 row_mask:0xf bank_mask:0xf
s_nop 1
v_add_f32_dpp v24, v24, v24 row_ror:2 row_mask:0xf bank_mask:0xf
s_nop 1
v_add_f32_dpp v24, v24, v24 row_ror:1 row_mask:0xf bank_mask:0xf
v_mov_b32 v5, v24
s_nop 1
v_permlane16_swap_b32 v24, v5
v_add_f32 v24, v24, v5
v_mov_b32 v5, v24
s_nop 1
v_permlane32_swap_b32 v24, v5
v_add_f32 v24, v24, v5
v_mul_f32 v24, 0x3b124925, v24
v_sub_f32 v16, v16, v24
v_sub_f32 v17, v17, v24
v_sub_f32 v18, v18, v24
v_sub_f32 v19, v19, v24
v_sub_f32 v20, v20, v24
v_sub_f32 v21, v21, v24
v_sub_f32 v22, v22, v24
v_mul_f32 v25, v16, v16
v_fmac_f32 v25, v17, v17
v_fmac_f32 v25, v18, v18
v_fmac_f32 v25, v19, v19
v_fmac_f32 v25, v20, v20
v_fmac_f32 v25, v21, v21
v_fmac_f32 v25, v22, v22
s_nop 1
v_add_f32_dpp v25, v25, v25 row_ror:8 row_mask:0xf bank_mask:0xf
s_nop 1
v_add_f32_dpp v25, v25, v25 row_ror:4 row_mask:0xf bank_mask:0xf
s_nop 1
v_add_f32_dpp v25, v25, v25 row_ror:2 row_mask:0xf bank_mask:0xf
s_nop 1
v_add_f32_dpp v25, v25, v25 row_ror:1 row_mask:0xf bank_mask:0xf
v_mov_b32 v5, v25
s_nop 1
v_permlane16_swap_b32 v25, v5
v_add_f32 v25, v25, v5
v_mov_b32 v5, v25
s_nop 1
v_permlane32_swap_b32 v25, v5
v_add_f32 v25, v25, v5
v_mul_f32 v25, 0x3b124925, v25
v_cvt_pk_bf16_f32 v25, 0, v25
v_cvt_pk_bf16_f32 v24, 0, v24
v_add_f32 v25, 0x3727c5ac, v25
v_sub_f32 v23, v23, v24
v_cvt_pk_bf16_f32 v25, 0, v25
v_cvt_pk_bf16_f32 v23, 0, v23
v_sqrt_f32 v25, v25
s_nop 0
v_cvt_pk_bf16_f32 v25, 0, v25
v_rcp_f32 v25, v25
s_nop 0
v_mul_f32 v23, v23, v25
v_cvt_pk_bf16_f32 v23, 0, v23
L_finm:
s_lshl_b32 s48, s52, 8
s_add_u32 s48, s48, 4096
s_sub_u32 s49, s52, 7
s_mov_b32 s97, 0
v_mov_b32 v3, 0
L_spin9:
ds_read_b32 v2, v3 offset:24
s_add_u32 s97, s97, 1
s_bitcmp1_b32 s97, 20
s_cbranch_scc1 L_end
s_waitcnt lgkmcnt(0)
v_cmp_ne_u32 vcc, 7, v2
s_cbranch_vccnz L_spin9
ds_read2st64_b32 v[16:17], v27 offset0:1 offset1:2
ds_read2st64_b32 v[18:19], v27 offset0:3 offset1:4
ds_read2st64_b32 v[20:21], v27 offset0:5 offset1:6
ds_read_b32 v22, v27 offset:1792
s_waitcnt lgkmcnt(2)
v_pk_add_f32 v[16:17], v[16:17], v[18:19]
s_waitcnt lgkmcnt(0)
v_add_f32 v20, v20, v22
v_pk_add_f32 v[16:17], v[16:17], v[20:21]
v_add_f32 v4, v16, v17
v_cvt_pk_bf16_f32 v4, 0, v4
s_cmp_ge_u32 s49, 7
s_cbranch_scc1 L_pubm
v_add_f32 v4, 1.0, v4
v_cvt_pk_bf16_f32 v4, 0, v4
v_mul_f32 v4, v23, v4
v_cvt_pk_bf16_f32 v4, 0, v4
L_pubm:
v_or_b32 v4, s34, v4
buffer_store_dword v4, v27, s[36:39], s48 offen sc1
s_branch L_qfetch
L_finq:
v_lshrrev_b32 v6, 5, v1
v_and_b32 v7, 1, v9
v_lshlrev_b32 v12, 3, v8
v_lshl_add_u32 v12, v6, 7, v12
v_lshl_add_u32 v12, v7, 2, v12
v_lshlrev_b32 v13, 2, v8
v_lshl_add_u32 v13, v6, 6, v13
v_lshlrev_b32 v14, 3, v8
v_lshl_add_u32 v14, v6, 2, v14
v_add_u32 v14, 0x80, v14
s_nop 1
v_mov_b32_dpp v13, v14 quad_perm:[0,1,2,3] row_mask:0xa bank_mask:0xf
v_mov_b32 v6, 0
v_writelane_b32 v6, s30, 16
s_waitcnt vmcnt(0)
s_mov_b32 s97, 0
v_mov_b32 v3, 0
L_gm10:
ds_read_b32 v2, v3 offset:52
s_add_u32 s97, s97, 1
s_bitcmp1_b32 s97, 20
s_cbranch_scc1 L_end
s_waitcnt lgkmcnt(0)
v_readfirstlane_b32 s96, v2
s_cmp_eq_u32 s96, 0
s_cbranch_scc1 L_gm10
s_mov_b32 s97, 0
v_mov_b32 v3, 0
L_spin11:
ds_read_b32 v2, v3 offset:24
s_add_u32 s97, s97, 1
s_bitcmp1_b32 s97, 20
s_cbranch_scc1 L_end
s_waitcnt lgkmcnt(0)
v_cmp_ne_u32 vcc, 7, v2
s_cbranch_vccnz L_spin11
ds_read2st64_b32 v[16:17], v12 offset0:1 offset1:2
ds_read2st64_b32 v[18:19], v12 offset0:3 offset1:4
ds_read2st64_b32 v[20:21], v12 offset0:5 offset1:6
ds_read_b32 v22, v12 offset:1792
s_waitcnt lgkmcnt(2)
v_pk_add_f32 v[16:17], v[16:17], v[18:19]
s_waitcnt lgkmcnt(0)
v_add_f32 v20, v20, v22
v_pk_add_f32 v[16:17], v[16:17], v[20:21]
v_add_f32 v4, v16, v17
v_mov_b32 v5, v4
s_nop 1
v_permlane16_swap_b32 v4, v5
v_cvt_pk_bf16_f32 v4, v4, v5
s_nop 1
v_xor_b32_dpp v5, v4, v4 row_ror:8 row_mask:0xf bank_mask:0xf
s_nop 1
v_xor_b32_dpp v5, v5, v5 row_ror:4 row_mask:0xf bank_mask:0xf
s_nop 1
v_xor_b32_dpp v5, v5, v5 row_ror:2 row_mask:0xf bank_mask:0xf
s_nop 1
v_xor_b32_dpp v5, v5, v5 row_ror:1 row_mask:0xf bank_mask:0xf
s_nop 1
v_xor_b32_dpp v4, v5, v6 quad_perm:[0,1,2,3] row_mask:0xa bank_mask:0xf
s_cmp_eq_u32 s96, 2
s_cbranch_scc0 L_sm12s
buffer_store_dword v4, v13, s[36:39], s53 offen offset:0
buffer_store_dword v4, v13, s[36:39], s53 offen offset:256
buffer_store_dword v4, v13, s[36:39], s53 offen offset:512
buffer_store_dword v4, v13, s[36:39], s53 offen offset:768
buffer_store_dword v4, v13, s[36:39], s53 offen offset:1024
buffer_store_dword v4, v13, s[36:39], s53 offen offset:1280
buffer_store_dword v4, v13, s[36:39], s53 offen offset:1536
buffer_store_dword v4, v13, s[36:39], s53 offen offset:1792
buffer_store_dword v4, v13, s[36:39], s53 offen offset:2048
buffer_store_dword v4, v13, s[36:39], s53 offen offset:2304
buffer_store_dword v4, v13, s[36:39], s53 offen offset:2560
buffer_store_dword v4, v13, s[36:39], s53 offen offset:2816
buffer_store_dword v4, v13, s[36:39], s53 offen offset:3072
buffer_store_dword v4, v13, s[36:39], s53 offen offset:3328
buffer_store_dword v4, v13, s[36:39], s53 offen offset:3584
buffer_store_dword v4, v13, s[36:39], s53 offen offset:3840
L_sm12d:
L_qfetch:
v_lshrrev_b32 v4, 3, v8
v_mul_u32_u24 v4, 576, v4
v_lshl_add_u32 v4, v9, 4, v4
s_lshl_b32 s49, s35, 13
s_add_u32 s49, s49, 39424
v_xor_b32 v12, v8, v9
v_lshlrev_b32 v12, 4, v12
v_lshl_add_u32 v12, v8, 9, v12
v_add_u32 v12, s49, v12
v_xor_b32 v13, 64, v12
v_xor_b32 v14, 0x80, v12
v_xor_b32 v15, 0xc0, v12
v_lshrrev_b32 v6, 5, v1
v_lshlrev_b32 v7, 2, v6
s_mul_i32 s49, s35, 4352
v_mul_u32_u24 v24, 272, v8
v_lshl_add_u32 v24, v6, 7, v24
v_and_b32 v10, 1, v9
v_mul_u32_u24 v10, 72, v10
v_add3_u32 v24, v24, v10, s49
s_lshl_b32 s49, s35, 2
v_lshl_add_u32 v10, v6, 6, s49
s_max_u32 s49, s49, 16
v_mov_b32 v26, s49
s_lshr_b32 s49, s35, 2
s_lshl_b32 s49, s49, 6
s_lshl_b32 s50, s35, 7
s_add_u32 s49, s49, s50
v_lshl_add_u32 v5, v9, 4, s49
s_lshl_b32 s48, s31, 3
s_add_u32 s48, s48, s35
s_lshl_b32 s48, s48, 4
s_getreg_b32 s49, hwreg(HW_REG_HW_ID, 8, 1)
s_add_u32 s49, s49, s48
s_lshl_b32 s49, s49, 8
s_add_u32 s49, s49, 1048576
s_add_u32 s94, s28, s49
s_addc_u32 s95, s29, 0
s_mov_b32 s97, 0
v_mov_b32 v3, 0
L_spin13:
ds_read_b32 v2, v3 offset:56
s_add_u32 s97, s97, 1
s_bitcmp1_b32 s97, 20
s_cbranch_scc1 L_end
s_waitcnt lgkmcnt(0)
v_cmp_ne_u32 vcc, 2, v2
s_cbranch_vccnz L_spin13
s_mov_b32 s97, 0
L_qp:
s_load_dwordx16 s[60:75], s[94:95], 0
s_load_dwordx16 s[76:91], s[94:95], 64
s_load_dwordx2 s[92:93], s[94:95], 128
L_qc:
s_waitcnt lgkmcnt(0)
s_xor_b64 s[92:93], s[92:93], s[60:61]
s_xor_b64 s[92:93], s[92:93], s[62:63]
s_xor_b64 s[92:93], s[92:93], s[64:65]
s_xor_b64 s[92:93], s[92:93], s[66:67]
s_xor_b64 s[92:93], s[92:93], s[68:69]
s_xor_b64 s[92:93], s[92:93], s[70:71]
s_xor_b64 s[92:93], s[92:93], s[72:73]
s_xor_b64 s[92:93], s[92:93], s[74:75]
s_xor_b64 s[92:93], s[92:93], s[76:77]
s_xor_b64 s[92:93], s[92:93], s[78:79]
s_xor_b64 s[92:93], s[92:93], s[80:81]
s_xor_b64 s[92:93], s[92:93], s[82:83]
s_xor_b64 s[92:93], s[92:93], s[84:85]
s_xor_b64 s[92:93], s[92:93], s[86:87]
s_xor_b64 s[92:93], s[92:93], s[88:89]
s_xor_b64 s[92:93], s[92:93], s[90:91]
s_xor_b32 s92, s92, s93
s_cmp_eq_u32 s92, s30
s_cbranch_scc1 L_qok
s_add_u32 s97, s97, 1
s_cmp_ge_u32 s97, 8
s_cbranch_scc1 L_qg
s_sleep 2
s_add_u32 s94, s94, 512
s_addc_u32 s95, s95, 0
s_cmp_lt_u32 s97, 5
s_cbranch_scc1 L_qp
s_sleep 6
s_branch L_qp
L_qok:
v_mov_b64 v[16:17], s[60:61]
v_mov_b64 v[18:19], s[62:63]
v_mov_b64 v[20:21], s[76:77]
v_mov_b64 v[22:23], s[78:79]
s_mov_b32 exec_lo, 0xffff0000
v_mov_b64 v[16:17], s[64:65]
v_mov_b64 v[18:19], s[66:67]
v_mov_b64 v[20:21], s[80:81]
v_mov_b64 v[22:23], s[82:83]
s_mov_b32 exec_lo, 0
v_mov_b64 v[16:17], s[68:69]
v_mov_b64 v[18:19], s[70:71]
v_mov_b64 v[20:21], s[84:85]
v_mov_b64 v[22:23], s[86:87]
s_mov_b32 exec_hi, 0xffff0000
v_mov_b64 v[16:17], s[72:73]
v_mov_b64 v[18:19], s[74:75]
v_mov_b64 v[20:21], s[88:89]
v_mov_b64 v[22:23], s[90:91]
s_mov_b32 exec_lo, 0x10001
s_mov_b32 exec_hi, 0x10001
ds_write_b128 v5, v[16:19] offset:3456
ds_write_b128 v5, v[20:23] offset:3520
v_mov_b32 v5, 1
s_mov_b64 exec, 1
ds_add_u32 v3, v5 offset:8
s_mov_b64 exec, -1
ds_read_b32 v2, v26 offset:176
s_waitcnt lgkmcnt(0)
v_cmp_ne_u32 vcc, 2, v2
s_cbranch_vccnz L_kl
ds_read_b128 v[64:67], v12 offset:0
ds_read_b128 v[68:71], v13 offset:0
ds_read_b128 v[72:75], v14 offset:0
ds_read_b128 v[76:79], v15 offset:0
ds_read_b128 v[80:83], v12 offset:256
ds_read_b128 v[84:87], v13 offset:256
ds_read_b128 v[88:91], v14 offset:256
ds_read_b128 v[92:95], v15 offset:256
s_mov_b32 s97, 0
v_mov_b32 v3, 0
L_spin14:
ds_read_b32 v2, v3 offset:8
s_add_u32 s97, s97, 1
s_bitcmp1_b32 s97, 20
s_cbranch_scc1 L_end
s_waitcnt lgkmcnt(0)
v_cmp_ne_u32 vcc, 8, v2
s_cbranch_vccnz L_spin14
ds_read_b128 v[32:35], v4 offset:3456
ds_read_b128 v[36:39], v4 offset:3520
ds_read_b128 v[40:43], v4 offset:3584
ds_read_b128 v[44:47], v4 offset:3648
ds_read_b128 v[48:51], v4 offset:3712
ds_read_b128 v[52:55], v4 offset:3776
ds_read_b128 v[56:59], v4 offset:3840
ds_read_b128 v[60:63], v4 offset:3904
s_branch L_qk
L_kl:
s_mov_b32 s97, 0
v_mov_b32 v3, 0
L_spin15:
ds_read_b32 v2, v3 offset:8
s_add_u32 s97, s97, 1
s_bitcmp1_b32 s97, 20
s_cbranch_scc1 L_end
s_waitcnt lgkmcnt(0)
v_cmp_ne_u32 vcc, 8, v2
s_cbranch_vccnz L_spin15
ds_read_b128 v[32:35], v4 offset:3456
ds_read_b128 v[36:39], v4 offset:3520
ds_read_b128 v[40:43], v4 offset:3584
ds_read_b128 v[44:47], v4 offset:3648
ds_read_b128 v[48:51], v4 offset:3712
ds_read_b128 v[52:55], v4 offset:3776
ds_read_b128 v[56:59], v4 offset:3840
ds_read_b128 v[60:63], v4 offset:3904
s_mov_b32 s97, 0
v_mov_b32 v3, 0
L_spin16:
ds_read_b32 v2, v26 offset:176
s_add_u32 s97, s97, 1
s_bitcmp1_b32 s97, 20
s_cbranch_scc1 L_end
s_waitcnt lgkmcnt(0)
v_cmp_ne_u32 vcc, 2, v2
s_cbranch_vccnz L_spin16
ds_read_b128 v[64:67], v12 offset:0
ds_read_b128 v[68:71], v13 offset:0
ds_read_b128 v[72:75], v14 offset:0
ds_read_b128 v[76:79], v15 offset:0
ds_read_b128 v[80:83], v12 offset:256
ds_read_b128 v[84:87], v13 offset:256
ds_read_b128 v[88:91], v14 offset:256
ds_read_b128 v[92:95], v15 offset:256
L_qk:
s_waitcnt lgkmcnt(7)
v_mfma_f32_16x16x32_bf16 v[16:19], v[32:35], v[64:67], 0
s_waitcnt lgkmcnt(6)
v_mfma_f32_16x16x32_bf16 v[16:19], v[36:39], v[68:71], v[16:19]
s_waitcnt lgkmcnt(5)
v_mfma_f32_16x16x32_bf16 v[16:19], v[40:43], v[72:75], v[16:19]
s_waitcnt lgkmcnt(4)
v_mfma_f32_16x16x32_bf16 v[16:19], v[44:47], v[76:79], v[16:19]
s_waitcnt lgkmcnt(3)
v_mfma_f32_16x16x32_bf16 v[16:19], v[48:51], v[80:83], v[16:19]
s_waitcnt lgkmcnt(2)
v_mfma_f32_16x16x32_bf16 v[16:19], v[52:55], v[84:87], v[16:19]
s_waitcnt lgkmcnt(1)
v_mfma_f32_16x16x32_bf16 v[16:19], v[56:59], v[88:91], v[16:19]
s_waitcnt lgkmcnt(0)
v_mfma_f32_16x16x32_bf16 v[16:19], v[60:63], v[92:95], v[16:19]
s_nop 7
v_cvt_pk_bf16_f32 v16, 0, v16
v_mul_f32 v16, 0x3d800000, v16
s_nop 1
v_max_f32_dpp v17, v16, v16 row_ror:8 row_mask:0xf bank_mask:0xf
s_nop 1
v_max_f32_dpp v17, v17, v17 row_ror:4 row_mask:0xf bank_mask:0xf
s_nop 1
v_max_f32_dpp v17, v17, v17 row_ror:2 row_mask:0xf bank_mask:0xf
s_nop 1
v_max_f32_dpp v17, v17, v17 row_ror:1 row_mask:0xf bank_mask:0xf
s_mov_b32 exec_lo, 1
s_mov_b32 exec_hi, 1
ds_max_f32 v7, v17 offset:32
s_mov_b32 exec_hi, 0
ds_add_u32 v3, v5 offset:12
s_mov_b64 exec, -1
s_mov_b32 s97, 0
L_mx:
ds_read_b32 v2, v3 offset:12
ds_read_b32 v17, v7 offset:32
s_add_u32 s97, s97, 1
s_bitcmp1_b32 s97, 20
s_cbranch_scc1 L_end
s_waitcnt lgkmcnt(0)
v_cmp_ne_u32 vcc, 8, v2
v_sub_f32 v18, v16, v17
s_cbranch_vccnz L_mx
v_mul_f32 v16, 0x3fb8aa3b, v18
v_exp_f32 v16, v16
s_nop 0
v_cvt_pk_bf16_f32 v18, v16, v16
ds_write_b16 v24, v18 offset:4608
v_add_f32_dpp v16, v16, v16 row_ror:8 row_mask:0xf bank_mask:0xf
ds_write_b16 v24, v18 offset:4626
s_nop 0
v_add_f32_dpp v16, v16, v16 row_ror:4 row_mask:0xf bank_mask:0xf
ds_write_b16 v24, v18 offset:4644
s_nop 0
v_add_f32_dpp v16, v16, v16 row_ror:2 row_mask:0xf bank_mask:0xf
ds_write_b16 v24, v18 offset:4662
s_nop 0
v_add_f32_dpp v16, v16, v16 row_ror:1 row_mask:0xf bank_mask:0xf
s_mov_b32 exec_lo, 1
s_mov_b32 exec_hi, 1
ds_write_b32 v10, v16 offset:64
s_mov_b32 exec_hi, 0
ds_add_u32 v3, v5 offset:16
s_mov_b64 exec, -1
s_sub_u32 s52, s32, 10
s_cmp_lt_u32 s52, 14
s_cbranch_scc1 L_wo
s_cmp_eq_u32 s33, 7
s_cbranch_scc1 L_end
s_cmp_lt_u32 s52, 18
s_cbranch_scc1 L_ffn
s_sub_u32 s53, s32, 18
s_cmp_lt_u32 s32, 10
s_cselect_b32 s53, s32, s53
s_mov_b32 s42, 1605632
s_lshl_b32 s48, s53, 2
s_add_u32 s48, s48, s35
s_cmp_lt_u32 s35, 4
s_cbranch_scc1 L_hw1
s_sub_u32 s48, s48, 4
s_lshl_b32 s48, s48, 12
s_mul_i32 s49, s33, 229376
s_add_u32 s48, s48, s49
v_lshlrev_b32 v4, 4, v1
s_mov_b64 s[40:41], s[18:19]
s_movk_i32 s49, 1024
s_branch L_hw2
L_hw1:
s_mul_i32 s48, s48, 7168
s_lshl_b32 s49, s33, 9
s_add_u32 s48, s48, s49
v_mul_u32_u24 v4, 3584, v6
v_and_b32 v5, 31, v1
v_lshl_add_u32 v4, v5, 4, v4
s_mov_b64 s[40:41], s[16:17]
s_mov_b32 s49, 401408
L_hw2:
s_mov_b32 s97, 0
v_mov_b32 v3, 0
L_spin17:
ds_read_b32 v2, v3 offset:44
s_add_u32 s97, s97, 1
s_bitcmp1_b32 s97, 20
s_cbranch_scc1 L_end
s_waitcnt lgkmcnt(0)
v_cmp_ne_u32 vcc, 2, v2
s_cbranch_vccnz L_spin17
buffer_load_dwordx4 v[16:19], v4, s[40:43], s48 offen
s_add_u32 s48, s48, s49
buffer_load_dwordx4 v[16:19], v4, s[40:43], s48 offen
s_add_u32 s48, s48, s49
buffer_load_dwordx4 v[16:19], v4, s[40:43], s48 offen
s_add_u32 s48, s48, s49
buffer_load_dwordx4 v[16:19], v4, s[40:43], s48 offen
s_add_u32 s48, s48, s49
s_branch L_end
L_svc:
v_lshrrev_b32 v6, 5, v1
v_lshlrev_b32 v7, 2, v6
s_lshl_b32 s50, s31, 12
s_add_u32 s50, s50, 36864
s_lshl_b32 s48, s32, 7
s_add_u32 s48, s48, s50
v_and_b32 v4, 3, v1
v_lshlrev_b32 v4, 5, v4
v_lshl_add_u32 v4, v6, 4, v4
v_mov_b32 v23, 0
v_lshlrev_b32 v5, 2, v8
v_lshl_add_u32 v5, v6, 6, v5
v_lshlrev_b32 v10, 3, v1
s_lshl_b32 s51, s31, 8
s_add_u32 s51, s51, 16384
s_getreg_b32 s52, hwreg(HW_REG_XCC_ID, 0, 4)
s_cmp_lg_u32 s32, 10
s_cbranch_scc1 L_sv1
s_mov_b32 exec_hi, 0
buffer_load_dwordx2 v[12:13], v10, s[36:39], s51 offen sc1
buffer_load_dwordx2 v[12:13], v10, s[36:39], s51 offen offset:2048 sc1
s_mov_b64 exec, -1
L_sv1:
s_lshl_b32 s53, s31, 5
s_add_u32 s53, s53, s32
s_lshl_b32 s53, s53, 11
s_add_u32 s53, s53, 524288
v_lshlrev_b32 v11, 6, v1
s_mov_b32 s49, 0xff800000
v_writelane_b32 v30, s49, 8
v_writelane_b32 v30, s49, 9
v_mov_b64 v[32:33], -1
v_mov_b64 v[34:35], -1
v_and_b32 v2, 0x7c, v27
ds_write_b32 v2, v32 offset:3328
s_waitcnt vmcnt(0)
v_readfirstlane_b32 s30, v17
s_and_b32 s49, s30, 0x7f7f7f7f
s_add_u32 s49, s49, 0x01010102
s_and_b32 s30, s30, 0x80808080
s_xor_b32 s30, s30, s49
s_or_b32 s30, s30, 1
v_writelane_b32 v30, s30, 10
s_and_b32 s34, s30, 0xffff
ds_write_b32 v27, v30
v_mov_b32 v14, s30
v_mov_b32 v15, s52
s_lshl_b32 s49, s32, 3
s_add_u32 s49, s49, s51
s_mov_b64 exec, 1
buffer_store_dwordx2 v[14:15], v10, s[36:39], s49 offen
s_mov_b64 exec, -1
s_waitcnt lgkmcnt(0)
s_barrier
s_mov_b32 s97, 0
v_mov_b32 v3, 0
L_spin18:
ds_read_b32 v2, v3 offset:48
s_add_u32 s97, s97, 1
s_bitcmp1_b32 s97, 20
s_cbranch_scc1 L_end
s_waitcnt lgkmcnt(0)
v_cmp_ne_u32 vcc, 2, v2
s_cbranch_vccnz L_spin18
L_sv2:
s_mov_b64 exec, 15
buffer_load_dword v16, v4, s[36:39], s48 offen sc1
s_mov_b32 exec_lo, -1
buffer_load_dword v16, v11, s[36:39], s53 offen sc1
s_mov_b32 s97, 0
s_mov_b32 s96, 1
L_hel:
buffer_load_dwordx2 v[12:13], v10, s[36:39], s51 offen sc1
s_add_u32 s97, s97, 1
s_waitcnt vmcnt(0)
v_cmp_ne_u64 vcc, v[12:13], v[14:15]
s_cbranch_vccz L_hel1
s_cmp_lt_u32 s97, 4
s_cbranch_scc1 L_hel
s_branch L_hel2
L_hel1:
s_mov_b32 s96, 2
L_hel2:
s_mov_b64 exec, -1
v_mov_b32 v2, s96
ds_write_b32 v23, v2 offset:52
v_mov_b32 v22, s30
v_lshlrev_b32 v11, 4, v1
s_cmp_eq_u32 s96, 2
s_cbranch_scc0 L_sm19s
buffer_store_dwordx4 v[32:35], v11, s[36:39], s53 offen
buffer_store_dwordx4 v[32:35], v11, s[36:39], s53 offen offset:1024
s_waitcnt vmcnt(0)
s_mov_b64 exec, 1
buffer_store_dwordx2 v[14:15], v10, s[36:39], s49 offen offset:2048
L_sm19d:
ds_write_b32 v23, v2 offset:0
s_mov_b64 exec, -1
s_mov_b32 s97, 0
L_sp:
ds_read_b32 v2, v23 offset:16
ds_read_b32 v21, v5 offset:64
ds_read_b32 v20, v7 offset:32
s_add_u32 s97, s97, 1
s_bitcmp1_b32 s97, 20
s_cbranch_scc1 L_end
s_waitcnt lgkmcnt(0)
v_cmp_ne_u32 vcc, 8, v2
v_or_b32 v20, s34, v20
s_cbranch_vccnz L_sp
s_cmp_eq_u32 s96, 2
v_add_f32_dpp v21, v21, v21 row_ror:8 row_mask:0xf bank_mask:0xf
s_nop 1
v_add_f32_dpp v21, v21, v21 row_ror:4 row_mask:0xf bank_mask:0xf
s_nop 1
v_add_f32_dpp v21, v21, v21 row_ror:2 row_mask:0xf bank_mask:0xf
s_nop 1
v_add_f32_dpp v21, v21, v21 row_ror:1 row_mask:0xf bank_mask:0xf
s_mov_b32 exec_lo, 15
s_mov_b32 exec_hi, 15
s_cbranch_scc0 L_sm20s
buffer_store_dwordx4 v[20:23], v4, s[36:39], s48 offen
L_sm20d:
s_mov_b64 exec, -1
s_sub_u32 s53, s32, 10
s_cmp_ge_u32 s53, 14
s_cbranch_scc1 L_end
s_cmp_ge_u32 s53, 7
s_cselect_b32 s48, 16, 0
s_add_u32 s50, s50, s48
v_lshlrev_b32 v11, 7, v1
v_and_b32 v7, 7, v1
v_lshrrev_b32 v5, 3, v1
v_lshlrev_b32 v4, 4, v7
v_lshl_add_u32 v4, v5, 2, v4
s_cmp_ge_u32 s53, 7
s_cselect_b32 s48, 7, 0
s_addc_u32 s69, s31, s31
s_sub_u32 s48, s53, s48
s_lshl_b32 s48, s48, 4
s_add_u32 s69, s69, s48
s_lshl_b32 s69, s69, 8
s_add_u32 s69, s69, 131072
v_lshlrev_b32 v60, 5, v7
v_and_b32 v2, 16, v1
v_add_u32 v60, v60, v2
v_lshl_add_u32 v60, v6, 3, v60
v_and_b32 v2, 1, v5
v_lshl_add_u32 v60, v2, 2, v60
v_mov_b32 v61, v27
v_lshlrev_b32 v62, 1, v61
v_bfe_u32 v62, s30, v62, 8
s_mov_b32 s55, 0xffffff00
s_lshr_b32 s60, s53, 1
s_and_b32 s61, s53, 1
s_lshl_b32 s48, s60, 6
s_lshl_b32 s49, s61, 1
s_add_u32 s48, s48, s49
v_lshl_add_u32 v27, v8, 1, v6
v_lshlrev_b32 v31, 2, v27
v_and_b32 v27, 7, v27
v_lshl_add_u32 v27, v27, 3, s48
v_bfe_u32 v30, v1, 3, 1
v_lshl_add_u32 v27, v30, 2, v27
v_bfe_u32 v30, v1, 2, 1
v_add_u32 v27, v27, v30
v_lshlrev_b32 v30, 1, v27
v_lshlrev_b32 v27, 2, v27
v_lshlrev_b32 v29, 4, v1
v_bfe_u32 v28, s30, v29, 8
v_add_u32 v29, 8, v29
v_bfe_u32 v29, s30, v29, 8
v_lshlrev_b32 v9, 8, v9
v_lshl_add_u32 v9, v8, 3, v9
v_lshlrev_b32 v8, 8, v5
v_lshl_add_u32 v8, v7, 3, v8
v_lshlrev_b32 v6, 3, v6
v_mov_b32 v23, s30
s_lshl_b32 s49, s61, 7
s_lshl_b32 s64, s60, 12
s_add_u32 s64, s64, s49
s_add_u32 s64, s64, 131072
s_lshl_b32 s65, s33, 11
s_add_u32 s65, s65, 20480
s_lshl_b32 s66, s53, 4
s_add_u32 s66, s66, s65
s_lshl_b32 s48, s53, 7
s_add_u32 s65, s65, s48
s_mul_i32 s67, s60, 7168
s_add_u32 s67, s67, s49
s_lshl_b32 s49, s33, 6
s_add_u32 s67, s67, s49
s_add_u32 s67, s67, 73728
s_add_u32 s68, s67, 4096
s_lshl_b32 s49, s33, 3
s_lshl_b32 s62, 0xff, s49
s_mov_b32 s63, s62
s_movk_i32 s48, 7680
s_movk_i32 s49, 13056
s_mov_b32 s97, 0
v_mov_b32 v3, 0
L_spin21:
ds_read_b32 v2, v3 offset:20
s_add_u32 s97, s97, 1
s_bitcmp1_b32 s97, 20
s_cbranch_scc1 L_end
s_waitcnt lgkmcnt(0)
v_cmp_ne_u32 vcc, 2, v2
s_cbranch_vccnz L_spin21
global_load_ushort v24, v30, s[4:5]
s_mov_b32 s97, 0
L_clp:
s_mov_b64 exec, -1
buffer_load_dword v25, v27, s[36:39], s48 offen sc1
buffer_load_dword v26, v27, s[36:39], s49 offen sc1
s_mov_b32 exec_hi, 0
buffer_load_dword v16, v10, s[36:39], s51 offen offset:2048 sc1
buffer_load_dwordx4 v[12:15], v11, s[36:39], s50 offen sc1
s_add_u32 s97, s97, 1
s_bitcmp1_b32 s97, 17
s_cbranch_scc1 L_end
s_waitcnt vmcnt(0)
v_cmp_ne_u32 s[52:53], s30, v16
s_mov_b64 exec, -1
v_xor_b32 v25, s34, v25
v_xor_b32 v26, s34, v26
v_or_b32 v2, v25, v26
v_cmp_ne_u16 vcc, 0, v2
s_or_b64 vcc, vcc, s[52:53]
s_cbranch_vccnz L_clp
v_mov_b32 v2, 1
v_lshlrev_b32 v24, 16, v24
s_mov_b32 exec_hi, 0
ds_write_b32 v3, v2 offset:4
s_branch L_mlc
L_mlp:
buffer_load_dwordx4 v[12:15], v11, s[36:39], s50 offen sc1
s_add_u32 s97, s97, 1
s_bitcmp1_b32 s97, 17
s_cbranch_scc1 L_end
s_waitcnt vmcnt(0)
L_mlc:
v_cmp_ne_u32 vcc, s30, v14
v_cmp_ne_u16 s[52:53], s34, v12
s_or_b64 exec, vcc, s[52:53]
s_cbranch_execnz L_mlp
s_mov_b64 exec, -1
v_and_b32 v12, 0xffff0000, v12
s_nop 1
v_max_f32_dpp v14, v12, v12 row_ror:8 row_mask:0xf bank_mask:0xf
s_nop 1
v_max_f32_dpp v14, v14, v14 row_ror:4 row_mask:0xf bank_mask:0xf
s_nop 1
v_max_f32_dpp v14, v14, v14 row_ror:2 row_mask:0xf bank_mask:0xf
s_nop 1
v_max_f32_dpp v14, v14, v14 row_ror:1 row_mask:0xf bank_mask:0xf
v_mov_b32 v5, v14
s_nop 1
v_permlane16_swap_b32 v14, v5
v_max_f32 v14, v14, v5
v_sub_f32 v12, v12, v14
v_mul_f32 v12, 0x3fb8aa3b, v12
v_exp_f32 v12, v12
s_nop 0
v_mul_f32 v13, v13, v12
s_nop 1
v_add_f32_dpp v13, v13, v13 row_ror:8 row_mask:0xf bank_mask:0xf
s_nop 1
v_add_f32_dpp v13, v13, v13 row_ror:4 row_mask:0xf bank_mask:0xf
s_nop 1
v_add_f32_dpp v13, v13, v13 row_ror:2 row_mask:0xf bank_mask:0xf
s_nop 1
v_add_f32_dpp v13, v13, v13 row_ror:1 row_mask:0xf bank_mask:0xf
v_mov_b32 v5, v13
s_nop 1
v_permlane16_swap_b32 v13, v5
v_add_f32 v13, v13, v5
v_rcp_f32 v13, v13
s_mov_b32 exec_hi, 0
v_mul_f32 v12, v12, v13
ds_write_b32 v4, v12 offset:3328
s_mov_b64 exec, -1
s_cmp_eq_u32 s33, 7
s_barrier
ds_read2st64_b32 v[12:13], v60 offset0:1 offset1:2
ds_read2st64_b32 v[14:15], v60 offset0:3 offset1:4
ds_read2st64_b32 v[16:17], v60 offset0:5 offset1:6
ds_read2st64_b32 v[18:19], v60 offset0:7 offset1:8
s_waitcnt lgkmcnt(2)
v_pk_add_f32 v[12:13], v[12:13], v[14:15]
s_waitcnt lgkmcnt(0)
v_pk_add_f32 v[16:17], v[16:17], v[18:19]
v_pk_add_f32 v[12:13], v[12:13], v[16:17]
v_add_f32 v12, v12, v13
v_and_or_b32 v63, v12, s55, v62
buffer_store_dword v63, v61, s[36:39], s69 offen sc1
s_cbranch_scc1 L_end
s_mov_b32 s97, 0
v_mov_b64 v[32:33], 0
buffer_atomic_add_x2 v[32:33], v9, s[36:39], s64 offen offset:0 sc0 sc1
v_mov_b64 v[34:35], 0
buffer_atomic_add_x2 v[34:35], v9, s[36:39], s64 offen offset:1024 sc0 sc1
v_mov_b64 v[36:37], 0
buffer_atomic_add_x2 v[36:37], v9, s[36:39], s64 offen offset:2048 sc0 sc1
v_mov_b64 v[38:39], 0
buffer_atomic_add_x2 v[38:39], v9, s[36:39], s64 offen offset:3072 sc0 sc1
s_sleep 5
v_mov_b64 v[40:41], 0
buffer_atomic_add_x2 v[40:41], v9, s[36:39], s64 offen offset:0 sc0 sc1
v_mov_b64 v[42:43], 0
buffer_atomic_add_x2 v[42:43], v9, s[36:39], s64 offen offset:1024 sc0 sc1
v_mov_b64 v[44:45], 0
buffer_atomic_add_x2 v[44:45], v9, s[36:39], s64 offen offset:2048 sc0 sc1
v_mov_b64 v[46:47], 0
buffer_atomic_add_x2 v[46:47], v9, s[36:39], s64 offen offset:3072 sc0 sc1
L_g22:
s_waitcnt vmcnt(4)
v_xor_b32 v12, v28, v32
v_xor_b32 v13, v29, v33
v_xor_b32 v14, v28, v34
v_xor_b32 v15, v29, v35
v_xor_b32 v16, v28, v36
v_xor_b32 v17, v29, v37
v_xor_b32 v18, v28, v38
v_xor_b32 v19, v29, v39
v_or3_b32 v20, v12, v13, v14
v_or3_b32 v21, v15, v16, v17
v_or3_b32 v20, v20, v18, v19
v_pk_add_f32 v[12:13], v[12:13], v[14:15]
v_or_b32 v20, v20, v21
v_pk_add_f32 v[16:17], v[16:17], v[18:19]
v_cmp_ne_u32_sdwa vcc, v20, 0 src0_sel:BYTE_0 src1_sel:DWORD
v_pk_add_f32 v[12:13], v[12:13], v[16:17]
s_cbranch_vccz L_g22d
v_mov_b64 v[32:33], 0
buffer_atomic_add_x2 v[32:33], v9, s[36:39], s64 offen offset:0 sc0 sc1
v_mov_b64 v[34:35], 0
buffer_atomic_add_x2 v[34:35], v9, s[36:39], s64 offen offset:1024 sc0 sc1
v_mov_b64 v[36:37], 0
buffer_atomic_add_x2 v[36:37], v9, s[36:39], s64 offen offset:2048 sc0 sc1
v_mov_b64 v[38:39], 0
buffer_atomic_add_x2 v[38:39], v9, s[36:39], s64 offen offset:3072 sc0 sc1
s_waitcnt vmcnt(4)
v_xor_b32 v12, v28, v40
v_xor_b32 v13, v29, v41
v_xor_b32 v14, v28, v42
v_xor_b32 v15, v29, v43
v_xor_b32 v16, v28, v44
v_xor_b32 v17, v29, v45
v_xor_b32 v18, v28, v46
v_xor_b32 v19, v29, v47
v_or3_b32 v20, v12, v13, v14
v_or3_b32 v21, v15, v16, v17
v_or3_b32 v20, v20, v18, v19
v_pk_add_f32 v[12:13], v[12:13], v[14:15]
v_or_b32 v20, v20, v21
v_pk_add_f32 v[16:17], v[16:17], v[18:19]
v_cmp_ne_u32_sdwa vcc, v20, 0 src0_sel:BYTE_0 src1_sel:DWORD
v_pk_add_f32 v[12:13], v[12:13], v[16:17]
s_cbranch_vccz L_g22d
v_mov_b64 v[40:41], 0
buffer_atomic_add_x2 v[40:41], v9, s[36:39], s64 offen offset:0 sc0 sc1
v_mov_b64 v[42:43], 0
buffer_atomic_add_x2 v[42:43], v9, s[36:39], s64 offen offset:1024 sc0 sc1
v_mov_b64 v[44:45], 0
buffer_atomic_add_x2 v[44:45], v9, s[36:39], s64 offen offset:2048 sc0 sc1
v_mov_b64 v[46:47], 0
buffer_atomic_add_x2 v[46:47], v9, s[36:39], s64 offen offset:3072 sc0 sc1
s_add_u32 s97, s97, 1
s_bitcmp1_b32 s97, 17
s_cbranch_scc1 L_end
s_branch L_g22
L_g22d:
s_nop 0
v_permlane32_swap_b32 v12, v13
v_add_f32 v14, v12, v13
v_add_f32 v12, v12, v13
s_nop 1
v_permlane16_swap_b32 v12, v14
v_add_f32 v12, v12, v14
v_fma_f32 v12, v25, v12, v24
s_cmp_eq_u32 s96, 2
v_cvt_pk_bf16_f32 v24, 0, v12
v_cvt_pk_bf16_f32 v22, 0, v12
v_mul_f32 v12, v24, v24
v_or_b32 v13, s34, v24
s_cbranch_scc0 L_sm23s
buffer_store_dword v13, v31, s[36:39], s65 offen
L_sm23d:
v_permlane32_swap_b32 v22, v12
v_add_f32 v22, v22, v12
s_nop 1
v_add_f32_dpp v22, v22, v22 row_ror:8 row_mask:0xf bank_mask:0xf
s_nop 1
v_add_f32_dpp v22, v22, v22 row_ror:4 row_mask:0xf bank_mask:0xf
s_nop 1
v_add_f32_dpp v22, v22, v22 row_ror:2 row_mask:0xf bank_mask:0xf
s_nop 1
v_add_f32_dpp v22, v22, v22 row_ror:1 row_mask:0xf bank_mask:0xf
s_mov_b32 exec_lo, 1
s_mov_b32 exec_hi, 1
s_cbranch_scc0 L_sm24s
buffer_store_dwordx2 v[22:23], v6, s[36:39], s66 offen offset:1792
L_sm24d:
s_mov_b64 exec, -1
s_cmp_ge_u32 s33, 2
s_cbranch_scc1 L_epoch
v_mov_b64 v[102:103], v[28:29]
v_mov_b64 v[110:111], v[28:29]
v_mov_b64 v[118:119], v[28:29]
v_mov_b64 v[126:127], v[28:29]
v_mov_b64 v[134:135], v[28:29]
s_mov_b32 s97, 0
v_mov_b64 v[96:97], 0
buffer_atomic_add_x2 v[96:97], v8, s[36:39], s67 offen offset:0 sc0 sc1
v_mov_b64 v[98:99], 0
buffer_atomic_add_x2 v[98:99], v8, s[36:39], s67 offen offset:2048 sc0 sc1
v_mov_b64 v[100:101], 0
buffer_atomic_add_x2 v[100:101], v8, s[36:39], s68 offen offset:0 sc0 sc1
s_mov_b32 exec_hi, 0x0
v_mov_b64 v[102:103], 0
buffer_atomic_add_x2 v[102:103], v8, s[36:39], s68 offen offset:2048 sc0 sc1
s_mov_b32 exec_hi, -1
s_sleep 1
v_mov_b64 v[104:105], 0
buffer_atomic_add_x2 v[104:105], v8, s[36:39], s67 offen offset:0 sc0 sc1
v_mov_b64 v[106:107], 0
buffer_atomic_add_x2 v[106:107], v8, s[36:39], s67 offen offset:2048 sc0 sc1
v_mov_b64 v[108:109], 0
buffer_atomic_add_x2 v[108:109], v8, s[36:39], s68 offen offset:0 sc0 sc1
s_mov_b32 exec_hi, 0x0
v_mov_b64 v[110:111], 0
buffer_atomic_add_x2 v[110:111], v8, s[36:39], s68 offen offset:2048 sc0 sc1
s_mov_b32 exec_hi, -1
s_sleep 1
v_mov_b64 v[112:113], 0
buffer_atomic_add_x2 v[112:113], v8, s[36:39], s67 offen offset:0 sc0 sc1
v_mov_b64 v[114:115], 0
buffer_atomic_add_x2 v[114:115], v8, s[36:39], s67 offen offset:2048 sc0 sc1
v_mov_b64 v[116:117], 0
buffer_atomic_add_x2 v[116:117], v8, s[36:39], s68 offen offset:0 sc0 sc1
s_mov_b32 exec_hi, 0x0
v_mov_b64 v[118:119], 0
buffer_atomic_add_x2 v[118:119], v8, s[36:39], s68 offen offset:2048 sc0 sc1
s_mov_b32 exec_hi, -1
s_sleep 1
v_mov_b64 v[120:121], 0
buffer_atomic_add_x2 v[120:121], v8, s[36:39], s67 offen offset:0 sc0 sc1
v_mov_b64 v[122:123], 0
buffer_atomic_add_x2 v[122:123], v8, s[36:39], s67 offen offset:2048 sc0 sc1
v_mov_b64 v[124:125], 0
buffer_atomic_add_x2 v[124:125], v8, s[36:39], s68 offen offset:0 sc0 sc1
s_mov_b32 exec_hi, 0x0
v_mov_b64 v[126:127], 0
buffer_atomic_add_x2 v[126:127], v8, s[36:39], s68 offen offset:2048 sc0 sc1
s_mov_b32 exec_hi, -1
s_sleep 1
v_mov_b64 v[128:129], 0
buffer_atomic_add_x2 v[128:129], v8, s[36:39], s67 offen offset:0 sc0 sc1
v_mov_b64 v[130:131], 0
buffer_atomic_add_x2 v[130:131], v8, s[36:39], s67 offen offset:2048 sc0 sc1
v_mov_b64 v[132:133], 0
buffer_atomic_add_x2 v[132:133], v8, s[36:39], s68 offen offset:0 sc0 sc1
s_mov_b32 exec_hi, 0x0
v_mov_b64 v[134:135], 0
buffer_atomic_add_x2 v[134:135], v8, s[36:39], s68 offen offset:2048 sc0 sc1
s_mov_b32 exec_hi, -1
L_g25:
s_waitcnt vmcnt(16)
v_xor_b32 v12, v28, v96
v_xor_b32 v13, v29, v97
v_xor_b32 v14, v28, v98
v_xor_b32 v15, v29, v99
v_xor_b32 v16, v28, v100
v_xor_b32 v17, v29, v101
v_xor_b32 v18, v28, v102
v_xor_b32 v19, v29, v103
v_or3_b32 v20, v12, v13, v14
v_or3_b32 v21, v15, v16, v17
v_or3_b32 v20, v20, v18, v19
v_pk_add_f32 v[12:13], v[12:13], v[14:15]
v_or_b32 v20, v20, v21
v_pk_add_f32 v[16:17], v[16:17], v[18:19]
v_cmp_ne_u32_sdwa vcc, v20, 0 src0_sel:BYTE_0 src1_sel:DWORD
v_pk_add_f32 v[12:13], v[12:13], v[16:17]
s_cbranch_vccz L_g25d
v_mov_b64 v[96:97], 0
buffer_atomic_add_x2 v[96:97], v8, s[36:39], s67 offen offset:0 sc0 sc1
v_mov_b64 v[98:99], 0
buffer_atomic_add_x2 v[98:99], v8, s[36:39], s67 offen offset:2048 sc0 sc1
v_mov_b64 v[100:101], 0
buffer_atomic_add_x2 v[100:101], v8, s[36:39], s68 offen offset:0 sc0 sc1
s_mov_b32 exec_hi, 0x0
v_mov_b64 v[102:103], 0
buffer_atomic_add_x2 v[102:103], v8, s[36:39], s68 offen offset:2048 sc0 sc1
s_mov_b32 exec_hi, -1
s_waitcnt vmcnt(16)
v_xor_b32 v12, v28, v104
v_xor_b32 v13, v29, v105
v_xor_b32 v14, v28, v106
v_xor_b32 v15, v29, v107
v_xor_b32 v16, v28, v108
v_xor_b32 v17, v29, v109
v_xor_b32 v18, v28, v110
v_xor_b32 v19, v29, v111
v_or3_b32 v20, v12, v13, v14
v_or3_b32 v21, v15, v16, v17
v_or3_b32 v20, v20, v18, v19
v_pk_add_f32 v[12:13], v[12:13], v[14:15]
v_or_b32 v20, v20, v21
v_pk_add_f32 v[16:17], v[16:17], v[18:19]
v_cmp_ne_u32_sdwa vcc, v20, 0 src0_sel:BYTE_0 src1_sel:DWORD
v_pk_add_f32 v[12:13], v[12:13], v[16:17]
s_cbranch_vccz L_g25d
v_mov_b64 v[104:105], 0
buffer_atomic_add_x2 v[104:105], v8, s[36:39], s67 offen offset:0 sc0 sc1
v_mov_b64 v[106:107], 0
buffer_atomic_add_x2 v[106:107], v8, s[36:39], s67 offen offset:2048 sc0 sc1
v_mov_b64 v[108:109], 0
buffer_atomic_add_x2 v[108:109], v8, s[36:39], s68 offen offset:0 sc0 sc1
s_mov_b32 exec_hi, 0x0
v_mov_b64 v[110:111], 0
buffer_atomic_add_x2 v[110:111], v8, s[36:39], s68 offen offset:2048 sc0 sc1
s_mov_b32 exec_hi, -1
s_waitcnt vmcnt(16)
v_xor_b32 v12, v28, v112
v_xor_b32 v13, v29, v113
v_xor_b32 v14, v28, v114
v_xor_b32 v15, v29, v115
v_xor_b32 v16, v28, v116
v_xor_b32 v17, v29, v117
v_xor_b32 v18, v28, v118
v_xor_b32 v19, v29, v119
v_or3_b32 v20, v12, v13, v14
v_or3_b32 v21, v15, v16, v17
v_or3_b32 v20, v20, v18, v19
v_pk_add_f32 v[12:13], v[12:13], v[14:15]
v_or_b32 v20, v20, v21
v_pk_add_f32 v[16:17], v[16:17], v[18:19]
v_cmp_ne_u32_sdwa vcc, v20, 0 src0_sel:BYTE_0 src1_sel:DWORD
v_pk_add_f32 v[12:13], v[12:13], v[16:17]
s_cbranch_vccz L_g25d
v_mov_b64 v[112:113], 0
buffer_atomic_add_x2 v[112:113], v8, s[36:39], s67 offen offset:0 sc0 sc1
v_mov_b64 v[114:115], 0
buffer_atomic_add_x2 v[114:115], v8, s[36:39], s67 offen offset:2048 sc0 sc1
v_mov_b64 v[116:117], 0
buffer_atomic_add_x2 v[116:117], v8, s[36:39], s68 offen offset:0 sc0 sc1
s_mov_b32 exec_hi, 0x0
v_mov_b64 v[118:119], 0
buffer_atomic_add_x2 v[118:119], v8, s[36:39], s68 offen offset:2048 sc0 sc1
s_mov_b32 exec_hi, -1
s_waitcnt vmcnt(16)
v_xor_b32 v12, v28, v120
v_xor_b32 v13, v29, v121
v_xor_b32 v14, v28, v122
v_xor_b32 v15, v29, v123
v_xor_b32 v16, v28, v124
v_xor_b32 v17, v29, v125
v_xor_b32 v18, v28, v126
v_xor_b32 v19, v29, v127
v_or3_b32 v20, v12, v13, v14
v_or3_b32 v21, v15, v16, v17
v_or3_b32 v20, v20, v18, v19
v_pk_add_f32 v[12:13], v[12:13], v[14:15]
v_or_b32 v20, v20, v21
v_pk_add_f32 v[16:17], v[16:17], v[18:19]
v_cmp_ne_u32_sdwa vcc, v20, 0 src0_sel:BYTE_0 src1_sel:DWORD
v_pk_add_f32 v[12:13], v[12:13], v[16:17]
s_cbranch_vccz L_g25d
v_mov_b64 v[120:121], 0
buffer_atomic_add_x2 v[120:121], v8, s[36:39], s67 offen offset:0 sc0 sc1
v_mov_b64 v[122:123], 0
buffer_atomic_add_x2 v[122:123], v8, s[36:39], s67 offen offset:2048 sc0 sc1
v_mov_b64 v[124:125], 0
buffer_atomic_add_x2 v[124:125], v8, s[36:39], s68 offen offset:0 sc0 sc1
s_mov_b32 exec_hi, 0x0
v_mov_b64 v[126:127], 0
buffer_atomic_add_x2 v[126:127], v8, s[36:39], s68 offen offset:2048 sc0 sc1
s_mov_b32 exec_hi, -1
s_waitcnt vmcnt(16)
v_xor_b32 v12, v28, v128
v_xor_b32 v13, v29, v129
v_xor_b32 v14, v28, v130
v_xor_b32 v15, v29, v131
v_xor_b32 v16, v28, v132
v_xor_b32 v17, v29, v133
v_xor_b32 v18, v28, v134
v_xor_b32 v19, v29, v135
v_or3_b32 v20, v12, v13, v14
v_or3_b32 v21, v15, v16, v17
v_or3_b32 v20, v20, v18, v19
v_pk_add_f32 v[12:13], v[12:13], v[14:15]
v_or_b32 v20, v20, v21
v_pk_add_f32 v[16:17], v[16:17], v[18:19]
v_cmp_ne_u32_sdwa vcc, v20, 0 src0_sel:BYTE_0 src1_sel:DWORD
v_pk_add_f32 v[12:13], v[12:13], v[16:17]
s_cbranch_vccz L_g25d
v_mov_b64 v[128:129], 0
buffer_atomic_add_x2 v[128:129], v8, s[36:39], s67 offen offset:0 sc0 sc1
v_mov_b64 v[130:131], 0
buffer_atomic_add_x2 v[130:131], v8, s[36:39], s67 offen offset:2048 sc0 sc1
v_mov_b64 v[132:133], 0
buffer_atomic_add_x2 v[132:133], v8, s[36:39], s68 offen offset:0 sc0 sc1
s_mov_b32 exec_hi, 0x0
v_mov_b64 v[134:135], 0
buffer_atomic_add_x2 v[134:135], v8, s[36:39], s68 offen offset:2048 sc0 sc1
s_mov_b32 exec_hi, -1
s_add_u32 s97, s97, 1
s_bitcmp1_b32 s97, 17
s_cbranch_scc1 L_end
s_branch L_g25
L_g25d:
s_nop 0
v_permlane32_swap_b32 v12, v13
v_add_f32 v14, v12, v13
v_add_f32 v12, v12, v13
s_nop 1
v_permlane16_swap_b32 v12, v14
v_add_f32 v12, v12, v14
s_nop 1
v_add_f32_dpp v12, v12, v12 row_ror:8 row_mask:0xf bank_mask:0xf
s_mov_b64 exec, s[62:63]
v_fma_f32 v12, v26, v12, v24
v_cvt_pk_bf16_f32 v12, v12, v12
global_store_short v30, v12, s[24:25]
s_endpgm
L_epoch:
s_cmp_lg_u32 s2, 82
s_cbranch_scc1 L_end
s_mov_b64 exec, 1
buffer_store_dword v23, v3, s[36:39], 0 offen sc1
s_branch L_end
L_wo:
s_cmp_ge_u32 s52, 7
s_cselect_b32 s51, 1, 0
s_lshr_b32 s48, s35, 2
s_lshl_b32 s48, s48, 7
s_and_b32 s49, s35, 1
s_lshl_b32 s49, s49, 6
s_add_u32 s48, s48, s49
s_and_b32 s49, s35, 2
s_lshl_b32 s49, s49, 1
s_add_u32 s48, s48, s49
s_lshl_b32 s48, s48, 7
s_add_u32 s48, s48, 104960
v_lshlrev_b32 v12, 11, v9
v_lshl_add_u32 v12, v8, 3, v12
v_add_u32 v12, s48, v12
ds_read_b64 v[32:33], v12 offset:0
ds_read_b64 v[34:35], v12 offset:128
ds_read_b64 v[36:37], v12 offset:256
ds_read_b64 v[38:39], v12 offset:384
ds_read_b64 v[40:41], v12 offset:1024
ds_read_b64 v[42:43], v12 offset:1152
ds_read_b64 v[44:45], v12 offset:1280
ds_read_b64 v[46:47], v12 offset:1408
v_lshrrev_b32 v4, 3, v1
v_and_b32 v5, 7, v1
v_lshlrev_b32 v10, 11, v4
v_lshl_add_u32 v10, v5, 4, v10
v_lshl_add_u32 v5, v5, 2, v9
v_lshl_add_u32 v5, v5, 1, s26
v_lshlrev_b32 v4, 4, v4
s_lshl_b32 s48, s31, 16
s_lshr_b32 s49, s35, 2
s_lshl_b32 s49, s49, 10
s_add_u32 s48, s48, s49
s_lshl_b32 s49, s51, 9
s_add_u32 s48, s48, s49
s_and_b32 s49, s35, 3
s_lshl_b32 s49, s49, 7
s_add_u32 s48, s48, s49
s_add_u32 s60, s48, 524288
s_add_u32 s61, s60, 0x4000
s_add_u32 s62, s60, 0x8000
s_add_u32 s63, s60, 0xc000
v_lshl_add_u32 v7, v8, 4, s27
v_lshl_add_u32 v11, v9, 4, s26
s_waitcnt lgkmcnt(0)
v_perm_b32 v64, v34, v32, s56
v_perm_b32 v68, v34, v32, s57
v_perm_b32 v72, v35, v33, s56
v_perm_b32 v76, v35, v33, s57
v_perm_b32 v65, v38, v36, s56
v_perm_b32 v69, v38, v36, s57
v_perm_b32 v73, v39, v37, s56
v_perm_b32 v77, v39, v37, s57
v_perm_b32 v66, v42, v40, s56
v_perm_b32 v70, v42, v40, s57
v_perm_b32 v74, v43, v41, s56
v_perm_b32 v78, v43, v41, s57
v_perm_b32 v67, v46, v44, s56
v_perm_b32 v71, v46, v44, s57
v_perm_b32 v75, v47, v45, s56
v_perm_b32 v79, v47, v45, s57
s_mov_b64 s[64:65], -1
s_mov_b64 s[66:67], -1
s_mov_b64 s[68:69], -1
s_mov_b64 s[70:71], -1
v_mov_b64 v[32:33], -1
v_mov_b64 v[34:35], -1
v_mov_b64 v[36:37], -1
v_mov_b64 v[38:39], -1
v_mov_b64 v[40:41], -1
v_mov_b64 v[42:43], -1
v_mov_b64 v[44:45], -1
v_mov_b64 v[46:47], -1
s_mov_b32 s97, 0
v_mov_b32 v3, 0
L_spin26:
ds_read_b32 v2, v3 offset:4
s_add_u32 s97, s97, 1
s_bitcmp1_b32 s97, 20
s_cbranch_scc1 L_end
s_waitcnt lgkmcnt(0)
v_cmp_ne_u32 vcc, 1, v2
s_cbranch_vccnz L_spin26
s_mov_b32 s97, 0
v_mov_b32 v3, 0
L_spin27:
ds_read_b32 v2, v3 offset:28
s_add_u32 s97, s97, 1
s_bitcmp1_b32 s97, 20
s_cbranch_scc1 L_end
s_waitcnt lgkmcnt(0)
v_cmp_ne_u32 vcc, 2, v2
s_cbranch_vccnz L_spin27
s_mov_b32 s97, 0
s_mov_b32 s59, 0
s_mov_b64 exec, s[64:65]
buffer_load_dwordx4 v[32:35], v10, s[36:39], s60 offen sc1
s_mov_b64 exec, s[66:67]
buffer_load_dwordx4 v[36:39], v10, s[36:39], s61 offen sc1
s_mov_b64 exec, s[68:69]
buffer_load_dwordx4 v[40:43], v10, s[36:39], s62 offen sc1
s_mov_b64 exec, s[70:71]
buffer_load_dwordx4 v[44:47], v10, s[36:39], s63 offen sc1
s_mov_b64 exec, -1
s_waitcnt vmcnt(0)
s_branch L_t1w
L_t1:
s_mov_b64 exec, s[64:65]
buffer_load_dwordx4 v[32:35], v10, s[36:39], s60 offen sc1
s_mov_b64 exec, s[66:67]
buffer_load_dwordx4 v[36:39], v10, s[36:39], s61 offen sc1
s_mov_b64 exec, s[68:69]
buffer_load_dwordx4 v[40:43], v10, s[36:39], s62 offen sc1
s_mov_b64 exec, s[70:71]
buffer_load_dwordx4 v[44:47], v10, s[36:39], s63 offen sc1
s_mov_b64 exec, -1
s_add_u32 s97, s97, 1
s_bitcmp1_b32 s97, 19
s_cbranch_scc1 L_end
L_t1w:
ds_read_b128 v[24:27], v4 offset:3328
s_waitcnt vmcnt(0) lgkmcnt(0)
v_cmp_eq_u32 s[64:65], -1, v35
v_cmp_eq_u32 s[66:67], -1, v39
v_cmp_eq_u32 s[68:69], -1, v43
v_cmp_eq_u32 s[70:71], -1, v47
v_cmp_eq_u32 vcc, -1, v27
s_or_b64 s[72:73], s[64:65], s[66:67]
s_or_b64 s[74:75], s[68:69], s[70:71]
s_or_b64 s[72:73], s[72:73], s[74:75]
s_or_b64 s[72:73], s[72:73], vcc
s_cbranch_scc1 L_t1
L_t1f:
v_pk_mul_f32 v[12:13], v[32:33], v[24:25] op_sel:[0,0] op_sel_hi:[1,0]
v_pk_mul_f32 v[14:15], v[34:35], v[24:25] op_sel:[0,0] op_sel_hi:[1,0]
v_pk_fma_f32 v[12:13], v[36:37], v[24:25], v[12:13] op_sel:[0,1,0] op_sel_hi:[1,1,1]
v_pk_fma_f32 v[14:15], v[38:39], v[24:25], v[14:15] op_sel:[0,1,0] op_sel_hi:[1,1,1]
v_pk_fma_f32 v[12:13], v[40:41], v[26:27], v[12:13] op_sel:[0,0,0] op_sel_hi:[1,0,1]
v_pk_fma_f32 v[14:15], v[42:43], v[26:27], v[14:15] op_sel:[0,0,0] op_sel_hi:[1,0,1]
v_pk_fma_f32 v[12:13], v[44:45], v[26:27], v[12:13] op_sel:[0,1,0] op_sel_hi:[1,1,1]
v_pk_fma_f32 v[14:15], v[46:47], v[26:27], v[14:15] op_sel:[0,1,0] op_sel_hi:[1,1,1]
s_nop 1
v_permlane32_swap_b32 v12, v14
v_permlane32_swap_b32 v13, v15
v_pk_add_f32 v[12:13], v[12:13], v[14:15]
s_nop 1
v_permlane16_swap_b32 v12, v13
v_add_f32 v12, v12, v13
s_nop 1
v_add_f32_dpp v12, v12, v12 row_ror:8 row_mask:0xf bank_mask:0xf
v_cvt_pk_bf16_f32 v13, v12, v12
v_cmp_u_f32 vcc, v12, v12
ds_write_b16 v5, v13
ds_read_b128 v[16:19], v11
s_cbranch_vccnz L_t1x
L_t1d:
s_waitcnt lgkmcnt(0)
v_mfma_f32_16x16x32_bf16 v[96:99], v[16:19], v[64:67], 0
v_mfma_f32_16x16x32_bf16 v[100:103], v[16:19], v[68:71], 0
v_mfma_f32_16x16x32_bf16 v[104:107], v[16:19], v[72:75], 0
v_mfma_f32_16x16x32_bf16 v[108:111], v[16:19], v[76:79], 0
s_nop 3
s_mov_b64 exec, 0xffff
s_nop 0
ds_write2_b32 v7, v96, v100 offset0:64 offset1:65
s_nop 0
ds_write2_b32 v7, v104, v108 offset0:66 offset1:67
s_mov_b64 exec, -1
s_waitcnt lgkmcnt(0)
s_barrier
s_endpgm
L_ffn:
s_cmp_ge_u32 s35, 7
s_cbranch_scc1 L_end
s_lshl_b32 s51, s33, 2
s_add_u32 s51, s51, s32
s_sub_u32 s51, s51, 24
s_mul_i32 s49, s51, 57344
s_lshl_b32 s50, s35, 7
s_add_u32 s49, s49, s50
v_lshrrev_b32 v4, 3, v1
v_and_b32 v6, 7, v1
v_lshlrev_b32 v5, 4, v6
v_mul_u32_u24 v13, 7168, v4
v_add_u32 v13, v13, v5
v_and_b32 v7, 28, v30
v_lshlrev_b32 v7, 2, v7
v_lshl_add_u32 v7, v6, 1, v7
v_add_u32 v7, s26, v7
v_mul_u32_u24 v14, 3584, v4
v_add_u32 v14, v14, v5
s_mul_i32 s48, s35, 229376
s_lshl_b32 s50, s51, 7
s_add_u32 s48, s48, s50
s_mov_b64 s[40:41], s[16:17]
s_mov_b32 s42, 1605632
s_mov_b64 s[44:45], s[18:19]
s_mov_b32 s46, 1605632
s_add_u32 s54, s27, 9472
s_mov_b32 s97, 0
L_pt28:
buffer_load_dword v24, v30, s[36:39], s54 offen sc1
buffer_load_dword v25, v30, s[36:39], s54 offen offset:1792 sc1
s_add_u32 s97, s97, 1
s_bitcmp1_b32 s97, 17
s_cbranch_scc1 L_end
s_waitcnt vmcnt(0)
v_xor_b32 v24, s34, v24
v_xor_b32 v25, s34, v25
v_or_b32 v2, v24, v25
v_cmp_ne_u16 vcc, 0, v2
s_cbranch_vccnz L_pt28
v_add_f32 v25, 1.0, v25
v_cvt_pk_bf16_f32 v25, 0, v25
s_lshl_b32 s53, s33, 11
s_add_u32 s53, s53, 20480
s_add_u32 s52, s53, s27
v_lshlrev_b32 v5, 4, v8
v_min_u32 v5, 0xd0, v5
v_mov_b32 v26, 0x3b124925
v_cmp_lt_u32 vcc, 13, v8
s_nop 1
v_cndmask_b32 v26, v26, 0, vcc
v_lshlrev_b32 v9, 1, v27
v_bfe_u32 v9, s30, v9, 8
s_mov_b32 s55, 0xffffff00
s_mov_b32 s97, 0
v_mov_b32 v3, 0
L_spin29:
ds_read_b32 v2, v3 offset:44
s_add_u32 s97, s97, 1
s_bitcmp1_b32 s97, 20
s_cbranch_scc1 L_end
s_waitcnt lgkmcnt(0)
v_cmp_ne_u32 vcc, 2, v2
s_cbranch_vccnz L_spin29
buffer_load_dword v144, v27, s[36:39], s52 offen sc1
buffer_load_dword v144, v5, s[36:39], s53 offen offset:1792 sc1
buffer_load_dwordx4 v[32:35], v14, s[40:43], s48 offen
s_add_u32 s48, s48, 28672
buffer_load_dwordx4 v[36:39], v14, s[40:43], s48 offen
s_add_u32 s48, s48, 28672
buffer_load_dwordx4 v[40:43], v14, s[40:43], s48 offen
s_add_u32 s48, s48, 28672
buffer_load_dwordx4 v[44:47], v14, s[40:43], s48 offen
s_add_u32 s48, s48, 28672
buffer_load_dwordx4 v[48:51], v14, s[40:43], s48 offen
s_add_u32 s48, s48, 28672
buffer_load_dwordx4 v[52:55], v14, s[40:43], s48 offen
s_add_u32 s48, s48, 28672
buffer_load_dwordx4 v[56:59], v14, s[40:43], s48 offen
s_add_u32 s48, s48, 28672
buffer_load_dwordx4 v[60:63], v14, s[40:43], s48 offen
L_fw2:
buffer_load_dwordx4 v[112:115], v13, s[44:47], s49 offen
s_add_u32 s49, s49, 896
buffer_load_dwordx4 v[116:119], v13, s[44:47], s49 offen
s_add_u32 s49, s49, 896
buffer_load_dwordx4 v[120:123], v13, s[44:47], s49 offen
s_add_u32 s49, s49, 896
buffer_load_dwordx4 v[124:127], v13, s[44:47], s49 offen
s_add_u32 s49, s49, 896
buffer_load_dwordx4 v[128:131], v13, s[44:47], s49 offen
s_add_u32 s49, s49, 896
buffer_load_dwordx4 v[132:135], v13, s[44:47], s49 offen
s_add_u32 s49, s49, 896
buffer_load_dwordx4 v[136:139], v13, s[44:47], s49 offen
s_add_u32 s49, s49, 896
buffer_load_dwordx4 v[140:143], v13, s[44:47], s49 offen
s_mul_i32 s48, s35, 7168
s_lshl_b32 s49, s51, 8
s_add_u32 s48, s48, s49
s_add_u32 s48, s48, 73728
v_mov_b32 v10, 0x3727c5ac
s_waitcnt vmcnt(8)
v_perm_b32 v64, v36, v32, s56
v_perm_b32 v68, v36, v32, s57
v_perm_b32 v72, v37, v33, s56
v_perm_b32 v76, v37, v33, s57
v_perm_b32 v80, v38, v34, s56
v_perm_b32 v84, v38, v34, s57
v_perm_b32 v88, v39, v35, s56
v_perm_b32 v92, v39, v35, s57
v_perm_b32 v65, v44, v40, s56
v_perm_b32 v69, v44, v40, s57
v_perm_b32 v73, v45, v41, s56
v_perm_b32 v77, v45, v41, s57
v_perm_b32 v81, v46, v42, s56
v_perm_b32 v85, v46, v42, s57
v_perm_b32 v89, v47, v43, s56
v_perm_b32 v93, v47, v43, s57
v_perm_b32 v66, v52, v48, s56
v_perm_b32 v70, v52, v48, s57
v_perm_b32 v74, v53, v49, s56
v_perm_b32 v78, v53, v49, s57
v_perm_b32 v82, v54, v50, s56
v_perm_b32 v86, v54, v50, s57
v_perm_b32 v90, v55, v51, s56
v_perm_b32 v94, v55, v51, s57
v_perm_b32 v67, v60, v56, s56
v_perm_b32 v71, v60, v56, s57
v_perm_b32 v75, v61, v57, s56
v_perm_b32 v79, v61, v57, s57
v_perm_b32 v83, v62, v58, s56
v_perm_b32 v87, v62, v58, s57
v_perm_b32 v91, v63, v59, s56
v_perm_b32 v95, v63, v59, s57
s_waitcnt vmcnt(6)
v_perm_b32 v32, v116, v112, s56
v_perm_b32 v36, v116, v112, s57
v_perm_b32 v40, v117, v113, s56
v_perm_b32 v44, v117, v113, s57
v_perm_b32 v48, v118, v114, s56
v_perm_b32 v52, v118, v114, s57
v_perm_b32 v56, v119, v115, s56
v_perm_b32 v60, v119, v115, s57
s_waitcnt vmcnt(4)
v_perm_b32 v33, v124, v120, s56
v_perm_b32 v37, v124, v120, s57
v_perm_b32 v41, v125, v121, s56
v_perm_b32 v45, v125, v121, s57
v_perm_b32 v49, v126, v122, s56
v_perm_b32 v53, v126, v122, s57
v_perm_b32 v57, v127, v123, s56
v_perm_b32 v61, v127, v123, s57
s_waitcnt vmcnt(2)
v_perm_b32 v34, v132, v128, s56
v_perm_b32 v38, v132, v128, s57
v_perm_b32 v42, v133, v129, s56
v_perm_b32 v46, v133, v129, s57
v_perm_b32 v50, v134, v130, s56
v_perm_b32 v54, v134, v130, s57
v_perm_b32 v58, v135, v131, s56
v_perm_b32 v62, v135, v131, s57
s_waitcnt vmcnt(0)
v_perm_b32 v35, v140, v136, s56
v_perm_b32 v39, v140, v136, s57
v_perm_b32 v43, v141, v137, s56
v_perm_b32 v47, v141, v137, s57
v_perm_b32 v51, v142, v138, s56
v_perm_b32 v55, v142, v138, s57
v_perm_b32 v59, v143, v139, s56
v_perm_b32 v63, v143, v139, s57
s_mov_b32 s97, 0
buffer_load_dword v112, v27, s[36:39], s52 offen sc1
buffer_load_dwordx4 v[116:119], v5, s[36:39], s53 offen offset:1792 sc1
s_sleep 1
L_xp:
s_add_u32 s97, s97, 1
s_bitcmp1_b32 s97, 17
s_cbranch_scc1 L_end
buffer_load_dword v120, v27, s[36:39], s52 offen sc1
buffer_load_dwordx4 v[124:127], v5, s[36:39], s53 offen offset:1792 sc1
s_waitcnt vmcnt(2)
v_xor_b32 v14, s34, v112
v_xor_b32 v15, s30, v117
v_xor_b32 v16, s30, v119
v_and_b32 v17, 0xffff, v14
v_mul_f32 v12, v26, v116
v_or3_b32 v15, v15, v16, v17
v_mul_f32 v13, v26, v118
v_cmp_ne_u32 vcc, 0, v15
s_cbranch_vccz L_xd
buffer_load_dword v112, v27, s[36:39], s52 offen sc1
buffer_load_dwordx4 v[116:119], v5, s[36:39], s53 offen offset:1792 sc1
s_waitcnt vmcnt(2)
v_xor_b32 v14, s34, v120
v_xor_b32 v15, s30, v125
v_xor_b32 v16, s30, v127
v_and_b32 v17, 0xffff, v14
v_mul_f32 v12, v26, v124
v_or3_b32 v15, v15, v16, v17
v_mul_f32 v13, v26, v126
v_cmp_ne_u32 vcc, 0, v15
s_cbranch_vccnz L_xp
L_xd:
v_add_f32_dpp v12, v12, v12 row_ror:8 row_mask:0xf bank_mask:0xf
v_add_f32_dpp v13, v13, v13 row_ror:8 row_mask:0xf bank_mask:0xf
s_nop 0
v_add_f32_dpp v12, v12, v12 row_ror:4 row_mask:0xf bank_mask:0xf
v_add_f32_dpp v13, v13, v13 row_ror:4 row_mask:0xf bank_mask:0xf
s_nop 0
v_add_f32_dpp v12, v12, v12 row_ror:2 row_mask:0xf bank_mask:0xf
v_add_f32_dpp v13, v13, v13 row_ror:2 row_mask:0xf bank_mask:0xf
s_nop 0
v_add_f32_dpp v12, v12, v12 row_ror:1 row_mask:0xf bank_mask:0xf
v_add_f32_dpp v13, v13, v13 row_ror:1 row_mask:0xf bank_mask:0xf
v_sub_f32 v14, v14, v12
v_fma_f32 v13, -v12, v12, v13
v_mul_f32 v14, v14, v25
v_max_f32 v13, 0, v13
v_add_f32 v13, v10, v13
v_rsq_f32 v13, v13
s_nop 0
v_fma_f32 v14, v14, v13, v24
v_cvt_pk_bf16_f32 v14, v14, v14
ds_write_b16 v7, v14
ds_read_b128 v[16:19], v11
ds_read_b128 v[20:23], v31
s_waitcnt lgkmcnt(1)
v_mfma_f32_16x16x32_bf16 v[96:99], v[16:19], v[64:67], 0
v_mfma_f32_16x16x32_bf16 v[100:103], v[16:19], v[68:71], 0
v_mfma_f32_16x16x32_bf16 v[104:107], v[16:19], v[72:75], 0
v_mfma_f32_16x16x32_bf16 v[108:111], v[16:19], v[76:79], 0
s_waitcnt lgkmcnt(0)
v_mfma_f32_16x16x32_bf16 v[96:99], v[20:23], v[80:83], v[96:99]
v_mfma_f32_16x16x32_bf16 v[100:103], v[20:23], v[84:87], v[100:103]
v_mfma_f32_16x16x32_bf16 v[104:107], v[20:23], v[88:91], v[104:107]
v_mfma_f32_16x16x32_bf16 v[108:111], v[20:23], v[92:95], v[108:111]
s_nop 6
v_permlane32_swap_b32 v96, v104
v_permlane32_swap_b32 v100, v108
s_nop 0
v_add_f32_dpp v96, v104, v96 row_ror:8 row_mask:0xf bank_mask:0x3
s_nop 1
v_add_f32_dpp v96, v100, v108 row_ror:8 row_mask:0xf bank_mask:0xc
ds_write_b32 v28, v96 offset:256
s_waitcnt lgkmcnt(0)
s_barrier
ds_read2st64_b32 v[12:13], v27 offset0:1 offset1:2
ds_read2st64_b32 v[14:15], v27 offset0:3 offset1:4
ds_read2st64_b32 v[16:17], v27 offset0:5 offset1:6
ds_read_b32 v18, v27 offset:1792
s_waitcnt lgkmcnt(2)
v_pk_add_f32 v[12:13], v[12:13], v[14:15]
s_waitcnt lgkmcnt(0)
v_add_f32 v16, v16, v18
v_pk_add_f32 v[12:13], v[12:13], v[16:17]
v_add_f32 v12, v12, v13
v_mul_f32 v13, 0xbfb8aa3b, v12
v_exp_f32 v13, v13
s_nop 0
v_add_f32 v13, 1.0, v13
v_rcp_f32 v13, v13
s_nop 0
v_mul_f32 v12, v12, v13
v_cvt_pk_bf16_f32 v12, v12, v12
ds_write_b16 v29, v12
ds_read_b128 v[16:19], v11
ds_read_b128 v[20:23], v31
s_waitcnt lgkmcnt(1)
v_mfma_f32_16x16x32_bf16 v[96:99], v[16:19], v[32:35], 0
v_mfma_f32_16x16x32_bf16 v[100:103], v[16:19], v[36:39], 0
v_mfma_f32_16x16x32_bf16 v[104:107], v[16:19], v[40:43], 0
v_mfma_f32_16x16x32_bf16 v[108:111], v[16:19], v[44:47], 0
s_waitcnt lgkmcnt(0)
v_mfma_f32_16x16x32_bf16 v[96:99], v[20:23], v[48:51], v[96:99]
v_mfma_f32_16x16x32_bf16 v[100:103], v[20:23], v[52:55], v[100:103]
v_mfma_f32_16x16x32_bf16 v[104:107], v[20:23], v[56:59], v[104:107]
v_mfma_f32_16x16x32_bf16 v[108:111], v[20:23], v[60:63], v[108:111]
s_nop 6
v_permlane32_swap_b32 v96, v104
v_permlane32_swap_b32 v100, v108
s_nop 0
v_add_f32_dpp v96, v104, v96 row_ror:8 row_mask:0xf bank_mask:0x3
s_nop 1
v_add_f32_dpp v96, v100, v108 row_ror:8 row_mask:0xf bank_mask:0xc
v_and_or_b32 v96, v96, s55, v9
buffer_store_dword v96, v27, s[36:39], s48 offen sc1
L_end:
L_exit:
s_endpgm
L_sm4s:
buffer_store_dwordx4 v[4:7], v3, s[36:39], s54 offen sc1
s_branch L_sm4d
L_sm12s:
buffer_store_dword v4, v13, s[36:39], s53 offen offset:0 sc1
buffer_store_dword v4, v13, s[36:39], s53 offen offset:256 sc1
buffer_store_dword v4, v13, s[36:39], s53 offen offset:512 sc1
buffer_store_dword v4, v13, s[36:39], s53 offen offset:768 sc1
buffer_store_dword v4, v13, s[36:39], s53 offen offset:1024 sc1
buffer_store_dword v4, v13, s[36:39], s53 offen offset:1280 sc1
buffer_store_dword v4, v13, s[36:39], s53 offen offset:1536 sc1
buffer_store_dword v4, v13, s[36:39], s53 offen offset:1792 sc1
buffer_store_dword v4, v13, s[36:39], s53 offen offset:2048 sc1
buffer_store_dword v4, v13, s[36:39], s53 offen offset:2304 sc1
buffer_store_dword v4, v13, s[36:39], s53 offen offset:2560 sc1
buffer_store_dword v4, v13, s[36:39], s53 offen offset:2816 sc1
buffer_store_dword v4, v13, s[36:39], s53 offen offset:3072 sc1
buffer_store_dword v4, v13, s[36:39], s53 offen offset:3328 sc1
buffer_store_dword v4, v13, s[36:39], s53 offen offset:3584 sc1
buffer_store_dword v4, v13, s[36:39], s53 offen offset:3840 sc1
s_branch L_sm12d
L_qg:
s_bitcmp1_b32 s97, 16
s_cbranch_scc1 L_end
buffer_load_dword v2, v27, s[36:39], s49 offen sc1
s_waitcnt vmcnt(0)
v_readlane_b32 s60, v2, 0
v_readlane_b32 s61, v2, 1
v_readlane_b32 s62, v2, 2
v_readlane_b32 s63, v2, 3
v_readlane_b32 s64, v2, 4
v_readlane_b32 s65, v2, 5
v_readlane_b32 s66, v2, 6
v_readlane_b32 s67, v2, 7
v_readlane_b32 s68, v2, 8
v_readlane_b32 s69, v2, 9
v_readlane_b32 s70, v2, 10
v_readlane_b32 s71, v2, 11
v_readlane_b32 s72, v2, 12
v_readlane_b32 s73, v2, 13
v_readlane_b32 s74, v2, 14
v_readlane_b32 s75, v2, 15
v_readlane_b32 s76, v2, 16
v_readlane_b32 s77, v2, 17
v_readlane_b32 s78, v2, 18
v_readlane_b32 s79, v2, 19
v_readlane_b32 s80, v2, 20
v_readlane_b32 s81, v2, 21
v_readlane_b32 s82, v2, 22
v_readlane_b32 s83, v2, 23
v_readlane_b32 s84, v2, 24
v_readlane_b32 s85, v2, 25
v_readlane_b32 s86, v2, 26
v_readlane_b32 s87, v2, 27
v_readlane_b32 s88, v2, 28
v_readlane_b32 s89, v2, 29
v_readlane_b32 s90, v2, 30
v_readlane_b32 s91, v2, 31
v_readlane_b32 s92, v2, 32
v_readlane_b32 s93, v2, 33
s_branch L_qc
L_sm19s:
buffer_store_dwordx4 v[32:35], v11, s[36:39], s53 offen sc1
buffer_store_dwordx4 v[32:35], v11, s[36:39], s53 offen offset:1024 sc1
s_waitcnt vmcnt(0)
s_mov_b64 exec, 1
buffer_store_dwordx2 v[14:15], v10, s[36:39], s49 offen offset:2048 sc1
s_branch L_sm19d
L_sm20s:
buffer_store_dwordx4 v[20:23], v4, s[36:39], s48 offen sc1
s_branch L_sm20d
L_sm23s:
buffer_store_dword v13, v31, s[36:39], s65 offen sc1
s_branch L_sm23d
L_sm24s:
buffer_store_dwordx2 v[22:23], v6, s[36:39], s66 offen offset:1792 sc1
s_branch L_sm24d
L_t1x:
s_cmp_eq_u32 s59, 1
s_cbranch_scc1 L_t1d
s_waitcnt vmcnt(0)
v_max3_u32 v13, v24, v25, v26
v_max3_u32 v13, v13, v32, v33
v_max3_u32 v13, v13, v34, v35
v_max3_u32 v13, v13, v36, v37
v_max3_u32 v13, v13, v38, v39
v_max3_u32 v13, v13, v40, v41
v_max3_u32 v13, v13, v42, v43
v_max3_u32 v13, v13, v44, v45
v_max3_u32 v13, v13, v46, v47
v_cmp_eq_u32 vcc, -1, v13
s_mov_b32 s59, 1
s_cbranch_vccz L_t1f
s_mov_b32 s59, 0
s_mov_b64 s[64:65], -1
s_mov_b64 s[66:67], -1
s_mov_b64 s[68:69], -1
s_mov_b64 s[70:71], -1
s_branch L_t1
L_last:
.section .rodata,"a"
.p2align 6
.amdhsa_kernel adaLN_cond__sliding_block_cached__dense_activation_silu__decode_kernel
.amdhsa_next_free_vgpr 168
.amdhsa_next_free_sgpr 102
.amdhsa_accum_offset 168
.amdhsa_group_segment_fixed_size 0
.amdhsa_kernarg_size 104
.amdhsa_float_denorm_mode_32 3
.amdhsa_user_sgpr_count 2
.amdhsa_user_sgpr_kernarg_segment_ptr 1
.amdhsa_system_sgpr_workgroup_id_x 1
.end_amdhsa_kernel
```
